```python
import torch

def _softmax(x, axis=-1):
    return torch.softmax(x, dim=axis)

def _gelu(x):
    return torch.nn.functional.gelu(x, approximate='tanh')

def _silu(x):
    return torch.nn.functional.silu(x)

def _sigmoid(x):
    return torch.sigmoid(x)

def _layernorm(x, axis=-1, eps=1e-05):
    m = x.mean(dim=axis, keepdim=True)
    v = x.var(dim=axis, keepdim=True, unbiased=False)
    return (x - m) / torch.sqrt(v + eps)

def _scatter_add(tgt, idx, src, axis=0):
    return tgt.clone().index_add_(axis, idx, src)

def _segment_sum(src, seg, n):
    out = torch.zeros((n,) + src.shape[1:], dtype=src.dtype)
    return out.index_add_(0, seg, src)

def _pad(x, pw):
    flat = tuple((v for pair in reversed(pw) for v in pair))
    return torch.nn.functional.pad(x, flat)
kernel_name = 'adaLN_cond__sliding_block_cached__dense_activation_silu__decode'

def setup_inputs():

    _w = lambda a: (lambda t: t.to(torch.bfloat16) if t.is_floating_point() else t)(torch.as_tensor(a))

    def _A_setup():
        B, Sq, D = (2, 1, 448)
        Hq, Hkv, Sk, Dh = (16, 8, 8192, 256)
        assert Hq % Hkv == 0, (Hq, Hkv)
        return {'x': _w((lambda *s: torch.randn(*s, dtype=torch.bfloat16) * 0.1)(B, Sq, D)), 'k_cache': _w((lambda *s: torch.randn(*s, dtype=torch.bfloat16) * 0.8)(B, Hkv, Sk, Dh)), 'v_cache': _w((lambda *s: torch.randn(*s, dtype=torch.bfloat16) * 3.2)(B, Hkv, Sk, Dh)), 'wq': _w((lambda *s: torch.randn(*s, dtype=torch.bfloat16) * 0.8)(D, Hq * Dh) * D ** (-0.5)), 'wo': _w((lambda *s: torch.randn(*s, dtype=torch.bfloat16) * 3.2)(Hq * Dh, D) * (Hq * Dh) ** (-0.5))}
    _A_in = _A_setup()

    def _B_setup():
        B, S, D, F = (2, 1, 448, 1792)
        return {'x': _w((lambda *s: torch.randn(*s, dtype=torch.bfloat16) * 0.1)(B, S, D)), 'w1': _w((lambda *s: torch.randn(*s, dtype=torch.bfloat16) * 3.2)(D, F) * D ** (-0.5)), 'w2': _w((lambda *s: torch.randn(*s, dtype=torch.bfloat16) * 3.2)(F, D) * F ** (-0.5))}
    _B_in = _B_setup()
    return {'A_x': _A_in['x'], 'A_k_cache': _A_in['k_cache'], 'A_v_cache': _A_in['v_cache'], 'A_wq': _A_in['wq'], 'A_wo': _A_in['wo'], 'B_x': _B_in['x'], 'B_w1': _B_in['w1'], 'B_w2': _B_in['w2'], 'c': _w((lambda *s: torch.randn(*s, dtype=torch.bfloat16) * 0.2)(2, 448) * 8.0), 'w_mod': _w((lambda *s: torch.randn(*s, dtype=torch.bfloat16) * 0.2)(448, 6 * 448) * 448 ** (-0.5) * 8.0)}

def reference(A_x, A_k_cache, A_v_cache, A_wq, A_wo, B_x, B_w1, B_w2, c, w_mod):

    def _A_ref(x, k_cache, v_cache, wq, wo):
        B, Sq, D = x.shape
        Hq, Dh = (16, 256)
        Hkv, Sk = (k_cache.shape[1], k_cache.shape[2])
        W = min(4096, max(256, Sk // 4))
        rep = Hq // Hkv
        q = (lambda x, *d: x.permute(*d))((x @ wq).reshape(B, Sq, Hq, Dh), 0, 2, 1, 3)
        k = (lambda x, n, axis: torch.repeat_interleave(x, n, dim=axis))(k_cache[:, :, Sk - W:, :], rep, axis=1)
        v = (lambda x, n, axis: torch.repeat_interleave(x, n, dim=axis))(v_cache[:, :, Sk - W:, :], rep, axis=1)
        scores = torch.einsum('bhqd,bhkd->bhqk', q, k) * Dh ** (-0.5)
        p = _softmax(scores, axis=-1)
        o = torch.einsum('bhqk,bhkd->bhqd', p, v)
        return (lambda x, *d: x.permute(*d))(o, 0, 2, 1, 3).reshape(B, Sq, Hq * Dh) @ wo

    def _B_ref(x, w1, w2):
        h = torch.einsum('bsd,df->bsf', x, w1)
        h = _silu(h)
        out = torch.einsum('bsf,fd->bsd', h, w2)
        return out
    x = A_x
    mod = (_silu(c) @ w_mod).reshape(c.shape[0], 6, 1, -1)
    sa, ca, ga, sb, cb, gb = (mod[:, 0].clone(), mod[:, 1].clone(), mod[:, 2].clone(), mod[:, 3].clone(), mod[:, 4].clone(), mod[:, 5].clone())
    h = _layernorm(x, axis=-1) * (1 + ca) + sa
    x = x + ga * _A_ref(h, A_k_cache, A_v_cache, A_wq, A_wo)
    h = _layernorm(x, axis=-1) * (1 + cb) + sb
    x = x + gb * _B_ref(h, B_w1, B_w2)
    return x
```

```asm
; @launch grid=(256,1,1) block=(512,1,1) lds=163840
.amdgcn_target "amdgcn-amd-amdhsa--gfx950"
.text
.globl adaLN_cond__sliding_block_cached__dense_activation_silu__decode_kernel
.p2align 8
.type adaLN_cond__sliding_block_cached__dense_activation_silu__decode_kernel,@function
adaLN_cond__sliding_block_cached__dense_activation_silu__decode_kernel:
    s_cmp_ge_u32 s2, 256
    s_cbranch_scc1 L_exit
    s_load_dwordx16 s[64:79], s[0:1], 0
    s_load_dwordx8 s[80:87], s[0:1], 64
    s_load_dwordx2 s[88:89], s[0:1], 96
    v_lshrrev_b32 v1, 6, v0
    v_and_b32 v0, 63, v0
    s_add_u32 s25, s2, 0
    s_and_b32 s25, s25, 7
    v_readfirstlane_b32 s3, v1
    v_and_b32 v1, 15, v0
    v_lshrrev_b32 v2, 4, v0
    s_lshr_b32 s24, s2, 3
    v_lshrrev_b32 v24, 3, v0
    v_and_b32 v26, 2, v24
    v_xor_b32 v26, v26, v0
    v_and_b32 v26, 7, v26
    v_lshlrev_b32 v26, 4, v26
    s_and_b32 s30, s3, 1
    s_lshl_b32 s32, s30, 6
    v_xor_b32 v26, s32, v26
    s_lshl_b32 s33, s3, 10
    v_lshlrev_b32 v3, 4, v0
    v_mov_b32 v9, 1073741824
    v_cmp_gt_u32 vcc, 56, v0
    s_cmp_lg_u32 s25, 0
    s_cbranch_scc1 L_notL
    s_cmp_ge_u32 s24, 28
    s_cbranch_scc1 L_exit
    v_cndmask_b32 v11, v9, v3, vcc
    s_cmp_ge_u32 s24, 14
    s_cselect_b32 s28, 1, 0
    s_mul_i32 s29, s28, 14
    s_sub_u32 s29, s24, s29
    s_lshl_b32 s31, s29, 7
    s_mul_i32 s32, s28, 1204224
    s_add_u32 s31, s31, s32
    s_mul_i32 s32, s3, 43008
    s_add_u32 s31, s31, s32
    s_movk_i32 s32, 5376
    v_mul_lo_u32 v25, v24, s32
    v_add_u32 v25, v25, v26
    s_mul_i32 s34, s30, 896
    s_mov_b32 s10, 2408448
    s_mov_b32 s11, 0x20000
    s_mov_b32 s14, 1792
    s_mov_b32 s15, 0x20000
    s_waitcnt lgkmcnt(0)
    s_mov_b32 s8, s82
    s_and_b32 s9, s83, 0xffff
    s_mov_b32 s12, s80
    s_and_b32 s13, s81, 0xffff
    buffer_load_dwordx4 v[12:15], v11, s[12:15], s34 offen
    s_add_u32 m0, s33, 0
    s_add_u32 s32, s31, 0
    buffer_load_dwordx4 v25, s[8:11], s32 offen nt lds
    s_add_u32 m0, s33, 8192
    s_add_u32 s32, s31, 344064
    buffer_load_dwordx4 v25, s[8:11], s32 offen nt lds
    s_add_u32 m0, s33, 16384
    s_add_u32 s32, s31, 688128
    buffer_load_dwordx4 v25, s[8:11], s32 offen nt lds
    s_cmp_lt_u32 s3, 4
    s_cbranch_scc0 L_if_1
    s_add_u32 m0, s33, 24576
    s_add_u32 s32, s31, 1032192
    buffer_load_dwordx4 v25, s[8:11], s32 offen nt lds
L_if_1:
    s_branch L_roleL
L_notL:
    s_mul_i32 s24, s24, 7
    s_add_u32 s24, s24, s25
    s_sub_u32 s24, s24, 1
    s_mov_b32 s39, 0
    s_cmp_lt_u32 s24, 64
    s_cbranch_scc1 L_Q_early
L_A_nm0:
L_A_nm:
    s_sub_u32 s24, s24, 64
    s_mul_i32 s26, s24, 6554
    s_lshr_b32 s26, s26, 16
    s_mul_i32 s27, s26, 10
    s_sub_u32 s27, s24, s27
    s_mul_i32 s28, s27, 12
    s_min_u32 s29, s27, 8
    s_add_u32 s28, s28, s29
    s_cmp_lt_u32 s27, 8
    s_cselect_b32 s29, 13, 12
    L_A_par:
    s_lshl_b32 s28, s28, 13
    s_lshl_b32 s32, s26, 22
    s_add_u32 s28, s28, s32
    s_add_u32 s28, s28, 3145728
    s_cmp_ge_u32 s3, 4
    s_cbranch_scc1 L_A_other
    v_lshrrev_b32 v3, 5, v0
    v_and_b32 v4, 31, v0
    v_xor_b32 v4, v4, v3
    v_lshlrev_b32 v4, 4, v4
    v_lshl_add_u32 v8, v3, 9, v4
    v_xor_b32 v9, 32, v8
    v_xor_b32 v10, 64, v8
    v_xor_b32 v11, 96, v8
    v_xor_b32 v12, 128, v8
    v_xor_b32 v13, 160, v8
    v_xor_b32 v14, 192, v8
    v_xor_b32 v15, 224, v8
    s_lshl_b32 s36, s3, 13
    s_add_u32 s36, s36, s28
    s_mul_i32 s31, s3, 32768
    s_waitcnt lgkmcnt(0)
    s_mov_b32 s12, s66
    s_and_b32 s13, s67, 0xffff
    s_mov_b32 s14, 67108864
    s_mov_b32 s15, 0x20000
    s_add_u32 m0, s31, 0
    s_add_u32 s32, s36, 0
    buffer_load_dwordx4 v8, s[12:15], s32 offen offset:0 nt lds
    buffer_load_dwordx4 v9, s[12:15], s32 offen offset:1024 nt lds
    s_waitcnt vmcnt(1)
    buffer_load_dwordx4 v10, s[12:15], s32 offen offset:2048 nt lds
    s_waitcnt vmcnt(1)
    buffer_load_dwordx4 v11, s[12:15], s32 offen offset:3072 nt lds
    s_add_u32 m0, s31, 4096
    s_add_u32 s32, s36, 4096
    buffer_load_dwordx4 v12, s[12:15], s32 offen offset:0 nt lds
    buffer_load_dwordx4 v13, s[12:15], s32 offen offset:1024 nt lds
    buffer_load_dwordx4 v14, s[12:15], s32 offen offset:2048 nt lds
    buffer_load_dwordx4 v15, s[12:15], s32 offen offset:3072 nt lds
L_kskip_2:
    s_add_u32 s32, s3, 4
    s_cmp_ge_u32 s32, s29
    s_cbranch_scc1 L_kskip_3
    s_add_u32 m0, s31, 8192
    s_add_u32 s32, s36, 32768
    s_waitcnt vmcnt(7)
    buffer_load_dwordx4 v8, s[12:15], s32 offen offset:0 nt lds
    s_waitcnt vmcnt(7)
    buffer_load_dwordx4 v9, s[12:15], s32 offen offset:1024 nt lds
    s_waitcnt vmcnt(7)
    buffer_load_dwordx4 v10, s[12:15], s32 offen offset:2048 nt lds
    s_waitcnt vmcnt(7)
    buffer_load_dwordx4 v11, s[12:15], s32 offen offset:3072 nt lds
    s_add_u32 m0, s31, 12288
    s_add_u32 s32, s36, 36864
    s_waitcnt vmcnt(7)
    buffer_load_dwordx4 v12, s[12:15], s32 offen offset:0 nt lds
    s_waitcnt vmcnt(7)
    buffer_load_dwordx4 v13, s[12:15], s32 offen offset:1024 nt lds
    s_waitcnt vmcnt(7)
    buffer_load_dwordx4 v14, s[12:15], s32 offen offset:2048 nt lds
    s_waitcnt vmcnt(7)
    buffer_load_dwordx4 v15, s[12:15], s32 offen offset:3072 nt lds
L_kskip_3:
    s_add_u32 s32, s3, 8
    s_cmp_ge_u32 s32, s29
    s_cbranch_scc1 L_kskip_4
    s_add_u32 m0, s31, 16384
    s_add_u32 s32, s36, 65536
    s_waitcnt vmcnt(7)
    buffer_load_dwordx4 v8, s[12:15], s32 offen offset:0 nt lds
    s_waitcnt vmcnt(7)
    buffer_load_dwordx4 v9, s[12:15], s32 offen offset:1024 nt lds
    s_waitcnt vmcnt(7)
    buffer_load_dwordx4 v10, s[12:15], s32 offen offset:2048 nt lds
    s_waitcnt vmcnt(7)
    buffer_load_dwordx4 v11, s[12:15], s32 offen offset:3072 nt lds
    s_add_u32 m0, s31, 20480
    s_add_u32 s32, s36, 69632
    s_waitcnt vmcnt(7)
    buffer_load_dwordx4 v12, s[12:15], s32 offen offset:0 nt lds
    s_waitcnt vmcnt(7)
    buffer_load_dwordx4 v13, s[12:15], s32 offen offset:1024 nt lds
    s_waitcnt vmcnt(7)
    buffer_load_dwordx4 v14, s[12:15], s32 offen offset:2048 nt lds
    s_waitcnt vmcnt(7)
    buffer_load_dwordx4 v15, s[12:15], s32 offen offset:3072 nt lds
L_kskip_4:
    s_add_u32 s32, s3, 12
    s_cmp_ge_u32 s32, s29
    s_cbranch_scc1 L_kskip_5
    s_add_u32 m0, s31, 24576
    s_add_u32 s32, s36, 98304
    s_waitcnt vmcnt(7)
    buffer_load_dwordx4 v8, s[12:15], s32 offen offset:0 nt lds
    s_waitcnt vmcnt(7)
    buffer_load_dwordx4 v9, s[12:15], s32 offen offset:1024 nt lds
    s_waitcnt vmcnt(7)
    buffer_load_dwordx4 v10, s[12:15], s32 offen offset:2048 nt lds
    s_waitcnt vmcnt(7)
    buffer_load_dwordx4 v11, s[12:15], s32 offen offset:3072 nt lds
    s_add_u32 m0, s31, 28672
    s_add_u32 s32, s36, 102400
    s_waitcnt vmcnt(7)
    buffer_load_dwordx4 v12, s[12:15], s32 offen offset:0 nt lds
    s_waitcnt vmcnt(7)
    buffer_load_dwordx4 v13, s[12:15], s32 offen offset:1024 nt lds
    s_waitcnt vmcnt(7)
    buffer_load_dwordx4 v14, s[12:15], s32 offen offset:2048 nt lds
    s_waitcnt vmcnt(7)
    buffer_load_dwordx4 v15, s[12:15], s32 offen offset:3072 nt lds
L_kskip_5:
    s_branch L_AK_go
L_Q_early:
    s_and_b32 s38, s24, 1
    s_lshr_b32 s37, s24, 1
    s_lshl_b32 s35, s37, 8
    s_mul_i32 s32, s38, 1835008
    s_add_u32 s35, s35, s32
    s_lshl_b32 s32, s3, 15
    s_add_u32 s35, s35, s32
    v_lshlrev_b32 v24, 1, v2
    v_xor_b32 v24, v24, v1
    s_and_b32 s32, s3, 2
    s_lshl_b32 s32, s32, 2
    v_xor_b32 v24, s32, v24
    v_lshlrev_b32 v24, 4, v24
    v_lshl_add_u32 v24, v2, 13, v24
    s_mov_b32 s10, 3670016
    s_mov_b32 s11, 0x20000
    v_cndmask_b32 v31, v9, v3, vcc
    v_cndmask_b32 v39, 0, 1.0, vcc
    s_mul_i32 s32, s30, 896
    v_min_u32 v28, 55, v0
    v_lshlrev_b32 v28, 2, v28
    s_mul_i32 s34, s38, 224
    v_add_u32 v30, s34, v28
    v_lshlrev_b32 v30, 1, v30
    s_mov_b32 s18, 1792
    s_mov_b32 s19, 0x20000
    s_waitcnt lgkmcnt(0)
    s_mov_b32 s16, s64
    s_and_b32 s17, s65, 0xffff
    s_mov_b32 s8, s70
    s_and_b32 s9, s71, 0xffff
    buffer_load_dwordx4 v[16:19], v31, s[16:19], s32 offen
    buffer_load_dwordx2 v[20:21], v30, s[16:19], s32 offen
    s_mov_b32 s4, s88
    s_and_b32 s5, s89, 0xffff
    s_mov_b32 s6, 268435456
    s_mov_b32 s7, 0x20000
    v_mov_b32 v4, -1
    v_mov_b32 v5, -1
    v_mov_b32 v6, -1
    v_mov_b32 v7, -1
    v_lshlrev_b32 v15, 2, v0
    s_mul_i32 s28, s24, 5120
    s_add_u32 s28, s28, 524288
    s_lshl_b32 s29, s24, 8
    s_add_u32 s29, s29, 98304
    s_add_u32 s32, s33, s28
    s_cmp_lt_u32 s3, 5
    s_cbranch_scc0 L_if_6
    buffer_store_dwordx4 v[4:7], v3, s[4:7], s32 offen sc1
L_if_6:
    s_cmp_eq_u32 s3, 5
    s_cbranch_scc0 L_if_7
    buffer_store_dword v4, v15, s[4:7], s29 offen sc1
L_if_7:
    s_add_u32 m0, s33, 65536
    s_add_u32 s32, s35, 0
    buffer_load_dwordx4 v24, s[8:11], s32 offen nt lds
    s_add_u32 m0, s33, 73728
    s_add_u32 s32, s35, 262144
    buffer_load_dwordx4 v24, s[8:11], s32 offen nt lds
    s_add_u32 m0, s33, 81920
    s_add_u32 s32, s35, 524288
    buffer_load_dwordx4 v24, s[8:11], s32 offen nt lds
    s_add_u32 m0, s33, 90112
    s_add_u32 s32, s35, 786432
    buffer_load_dwordx4 v24, s[8:11], s32 offen nt lds
    s_add_u32 m0, s33, 98304
    s_add_u32 s32, s35, 1048576
    buffer_load_dwordx4 v24, s[8:11], s32 offen nt lds
    s_add_u32 m0, s33, 106496
    s_add_u32 s32, s35, 1310720
    buffer_load_dwordx4 v24, s[8:11], s32 offen nt lds
    s_add_u32 m0, s33, 114688
    s_add_u32 s32, s35, 1572864
    buffer_load_dwordx4 v24, s[8:11], s32 offen nt lds
    s_branch L_roleQ
L_AK_go:
    s_barrier
L_AK_post:
    s_mov_b32 s4, s88
    s_and_b32 s5, s89, 0xffff
    s_mov_b32 s6, 268435456
    s_mov_b32 s7, 0x20000
    s_mul_i32 s31, s3, 32768
    v_xor_b32 v3, v1, v2
    v_lshlrev_b32 v3, 4, v3
    v_lshl_add_u32 v3, v1, 9, v3
    v_add_u32 v4, s31, v3
    v_xor_b32 v5, 64, v4
    v_xor_b32 v6, 0x80, v4
    v_xor_b32 v7, 0xc0, v4
    v_lshrrev_b32 v8, 3, v1
    v_lshlrev_b32 v9, 9, v8
    v_lshl_add_u32 v9, v2, 4, v9
    v_add_u32 v9, 131072, v9
    s_lshl_b32 s32, s3, 4
    v_lshlrev_b32 v10, 6, v8
    v_lshl_add_u32 v11, v2, 2, v10
    v_add_u32 v11, s32, v11
    v_add_u32 v11, 132096, v11
    v_add_u32 v10, 132096, v10
    v_lshlrev_b32 v12, 4, v0
    v_add_u32 v12, s31, v12
    s_mov_b32 s33, 0x3db8aa3b
    v_mov_b32 v28, 132352
    v_cmp_eq_u32 vcc, 0, v0
    v_lshlrev_b32 v31, 2, v0
    v_add_u32 v31, 132608, v31
    v_cndmask_b32 v29, 0, 1, vcc
    v_cndmask_b32 v31, v31, v28, vcc
    v_bfe_u32 v14, v1, 1, 2
    v_and_b32 v15, 1, v1
    v_mov_b32 v16, 0xffff
    v_lshlrev_b32 v15, 4, v15
    v_lshlrev_b32 v15, v15, v16
    v_and_b32 v14, 7, v1
    v_lshl_add_u32 v208, v14, 1, v12
    v_mov_b32 v212, 0
    v_mov_b32 v213, 0
    v_mov_b32 v214, 0
    v_mov_b32 v215, 0
    s_lshr_b32 s34, s26, 3
    s_and_b32 s35, s26, 7
    s_lshl_b32 s35, s35, 1
    v_add_u32 v13, s35, v8
    v_mul_u32_u24 v13, 4, v13
    v_add_u32 v13, v13, v2
    v_lshlrev_b32 v13, 1, v13
    v_add_u32 v13, s34, v13
    v_lshlrev_b32 v13, 4, v13
    v_add_u32 v13, s27, v13
    v_lshlrev_b32 v13, 3, v13
    v_add_u32 v13, 98304, v13
    v_and_b32 v14, 7, v1
    v_cmp_ne_u32 vcc, 0, v14
    v_cmp_le_u32 s[36:37], 4, v2
    s_or_b64 vcc, vcc, s[36:37]
    v_mov_b32 v14, 1073741824
    s_nop 0
    v_cndmask_b32 v13, v13, v14, vcc
    s_mov_b64 exec, 0
L_AK_top:
    v_mov_b32 v204, 0xff800000
    v_mov_b32 v205, 0xff800000
    v_mov_b32 v206, 0xff800000
    v_mov_b32 v207, 0xff800000
    s_mov_b32 s93, 1600000
L_lw_8:
    ds_read_b32 v30, v28 offset:0
    s_waitcnt lgkmcnt(0)
    v_cmp_gt_u32 vcc, 1, v30
    s_cbranch_vccz L_pd_9
    s_sub_u32 s93, s93, 1
    s_cmp_gt_i32 s93, 0
    s_cbranch_scc1 L_lw_8
L_pd_9:
    ds_read_b128 v[32:35], v9 offset:0
    ds_read_b128 v[36:39], v9 offset:64
    ds_read_b128 v[40:43], v9 offset:128
    ds_read_b128 v[44:47], v9 offset:192
    ds_read_b128 v[48:51], v9 offset:256
    ds_read_b128 v[52:55], v9 offset:320
    ds_read_b128 v[56:59], v9 offset:384
    ds_read_b128 v[60:63], v9 offset:448
    s_waitcnt lgkmcnt(7)
    v_mfma_f32_16x16x32_bf16 v[192:195], v[64:67], v[32:35], 0
    s_waitcnt lgkmcnt(6)
    v_mfma_f32_16x16x32_bf16 v[192:195], v[68:71], v[36:39], v[192:195]
    s_waitcnt lgkmcnt(5)
    v_mfma_f32_16x16x32_bf16 v[192:195], v[72:75], v[40:43], v[192:195]
    s_waitcnt lgkmcnt(4)
    v_mfma_f32_16x16x32_bf16 v[192:195], v[76:79], v[44:47], v[192:195]
    s_waitcnt lgkmcnt(3)
    v_mfma_f32_16x16x32_bf16 v[192:195], v[80:83], v[48:51], v[192:195]
    s_waitcnt lgkmcnt(2)
    v_mfma_f32_16x16x32_bf16 v[192:195], v[84:87], v[52:55], v[192:195]
    s_waitcnt lgkmcnt(1)
    v_mfma_f32_16x16x32_bf16 v[192:195], v[88:91], v[56:59], v[192:195]
    s_waitcnt lgkmcnt(0)
    v_mfma_f32_16x16x32_bf16 v[192:195], v[92:95], v[60:63], v[192:195]
    v_mfma_f32_16x16x32_bf16 v[196:199], v[96:99], v[32:35], 0
    v_mfma_f32_16x16x32_bf16 v[196:199], v[100:103], v[36:39], v[196:199]
    v_mfma_f32_16x16x32_bf16 v[196:199], v[104:107], v[40:43], v[196:199]
    v_mfma_f32_16x16x32_bf16 v[196:199], v[108:111], v[44:47], v[196:199]
    v_mfma_f32_16x16x32_bf16 v[196:199], v[112:115], v[48:51], v[196:199]
    v_mfma_f32_16x16x32_bf16 v[196:199], v[116:119], v[52:55], v[196:199]
    v_mfma_f32_16x16x32_bf16 v[196:199], v[120:123], v[56:59], v[196:199]
    v_mfma_f32_16x16x32_bf16 v[196:199], v[124:127], v[60:63], v[196:199]
    v_mfma_f32_16x16x32_bf16 v[200:203], v[128:131], v[32:35], 0
    v_cvt_pk_bf16_f32 v16, v192, v193
    v_mfma_f32_16x16x32_bf16 v[200:203], v[132:135], v[36:39], v[200:203]
    v_cvt_pk_bf16_f32 v17, v194, v195
    v_mfma_f32_16x16x32_bf16 v[200:203], v[136:139], v[40:43], v[200:203]
    v_lshlrev_b32 v192, 16, v16
    v_mfma_f32_16x16x32_bf16 v[200:203], v[140:143], v[44:47], v[200:203]
    v_and_b32 v193, 0xffff0000, v16
    v_mfma_f32_16x16x32_bf16 v[200:203], v[144:147], v[48:51], v[200:203]
    v_lshlrev_b32 v194, 16, v17
    v_mfma_f32_16x16x32_bf16 v[200:203], v[148:151], v[52:55], v[200:203]
    v_and_b32 v195, 0xffff0000, v17
    v_mfma_f32_16x16x32_bf16 v[200:203], v[152:155], v[56:59], v[200:203]
    v_max3_f32 v14, v192, v193, v194
    v_mfma_f32_16x16x32_bf16 v[200:203], v[156:159], v[60:63], v[200:203]
    v_max_f32 v14, v14, v195
    s_add_u32 s32, s3, 12
    s_cmp_lt_u32 s32, s29
    s_cbranch_scc0 L_if_10
    v_mfma_f32_16x16x32_bf16 v[204:207], v[160:163], v[32:35], 0
    v_mfma_f32_16x16x32_bf16 v[204:207], v[164:167], v[36:39], v[204:207]
    v_mfma_f32_16x16x32_bf16 v[204:207], v[168:171], v[40:43], v[204:207]
    v_mfma_f32_16x16x32_bf16 v[204:207], v[172:175], v[44:47], v[204:207]
    v_mfma_f32_16x16x32_bf16 v[204:207], v[176:179], v[48:51], v[204:207]
    v_mfma_f32_16x16x32_bf16 v[204:207], v[180:183], v[52:55], v[204:207]
    v_mfma_f32_16x16x32_bf16 v[204:207], v[184:187], v[56:59], v[204:207]
    v_mfma_f32_16x16x32_bf16 v[204:207], v[188:191], v[60:63], v[204:207]
L_if_10:
    v_cvt_pk_bf16_f32 v16, v196, v197
    v_cvt_pk_bf16_f32 v17, v198, v199
    v_lshlrev_b32 v196, 16, v16
    v_and_b32 v197, 0xffff0000, v16
    v_lshlrev_b32 v198, 16, v17
    v_and_b32 v199, 0xffff0000, v17
    v_max3_f32 v14, v14, v196, v197
    v_max3_f32 v14, v14, v198, v199
    v_cvt_pk_bf16_f32 v16, v200, v201
    v_cvt_pk_bf16_f32 v17, v202, v203
    v_lshlrev_b32 v200, 16, v16
    v_and_b32 v201, 0xffff0000, v16
    v_lshlrev_b32 v202, 16, v17
    v_and_b32 v203, 0xffff0000, v17
    v_max3_f32 v14, v14, v200, v201
    v_max3_f32 v14, v14, v202, v203
    v_cvt_pk_bf16_f32 v16, v204, v205
    v_cvt_pk_bf16_f32 v17, v206, v207
    v_lshlrev_b32 v204, 16, v16
    v_and_b32 v205, 0xffff0000, v16
    v_lshlrev_b32 v206, 16, v17
    v_and_b32 v207, 0xffff0000, v17
    v_max3_f32 v14, v14, v204, v205
    v_max3_f32 v14, v14, v206, v207
    ds_write_b32 v11, v14
    s_waitcnt lgkmcnt(0)
    ds_add_u32 v31, v29 offset:4
    s_mov_b32 s93, 1600000
L_lw_11:
    ds_read_b32 v30, v28 offset:4
    s_waitcnt lgkmcnt(0)
    v_cmp_gt_u32 vcc, 4, v30
    s_cbranch_vccz L_pd_12
    s_sub_u32 s93, s93, 1
    s_cmp_gt_i32 s93, 0
    s_cbranch_scc1 L_lw_11
L_pd_12:
    ds_read_b128 v[32:35], v10 offset:0
    ds_read_b128 v[36:39], v10 offset:16
    ds_read_b128 v[40:43], v10 offset:32
    ds_read_b128 v[44:47], v10 offset:48
    s_waitcnt lgkmcnt(0)
    v_max3_f32 v14, v32, v33, v34
    v_max3_f32 v15, v35, v36, v37
    v_max3_f32 v14, v14, v38, v39
    v_max3_f32 v15, v15, v40, v41
    v_max3_f32 v14, v14, v42, v43
    v_max3_f32 v15, v15, v44, v45
    v_max3_f32 v14, v14, v46, v47
    v_max_f32 v14, v14, v15
    v_mul_f32 v48, s33, v14
    v_fma_f32 v192, v192, s33, -v48
    v_fma_f32 v193, v193, s33, -v48
    v_fma_f32 v194, v194, s33, -v48
    v_fma_f32 v195, v195, s33, -v48
    v_fma_f32 v196, v196, s33, -v48
    v_fma_f32 v197, v197, s33, -v48
    v_fma_f32 v198, v198, s33, -v48
    v_fma_f32 v199, v199, s33, -v48
    v_fma_f32 v200, v200, s33, -v48
    v_fma_f32 v201, v201, s33, -v48
    v_fma_f32 v202, v202, s33, -v48
    v_fma_f32 v203, v203, s33, -v48
    v_fma_f32 v204, v204, s33, -v48
    v_fma_f32 v205, v205, s33, -v48
    v_fma_f32 v206, v206, s33, -v48
    v_fma_f32 v207, v207, s33, -v48
    v_exp_f32 v192, v192
    v_exp_f32 v193, v193
    v_exp_f32 v194, v194
    v_exp_f32 v195, v195
    v_exp_f32 v196, v196
    v_exp_f32 v197, v197
    v_exp_f32 v198, v198
    v_exp_f32 v199, v199
    v_exp_f32 v200, v200
    v_exp_f32 v201, v201
    v_exp_f32 v202, v202
    v_exp_f32 v203, v203
    v_exp_f32 v204, v204
    v_exp_f32 v205, v205
    v_exp_f32 v206, v206
    v_exp_f32 v207, v207
    v_cvt_pk_bf16_f32 v32, v192, v193
    v_cvt_pk_bf16_f32 v33, v194, v195
    ds_write_b16 v208, v32 offset:0
    ds_write_b16_d16_hi v208, v32 offset:1024
    ds_write_b16 v208, v33 offset:2048
    ds_write_b16_d16_hi v208, v33 offset:3072
    v_cvt_pk_bf16_f32 v34, v196, v197
    v_cvt_pk_bf16_f32 v35, v198, v199
    ds_write_b16 v208, v34 offset:8192
    ds_write_b16_d16_hi v208, v34 offset:9216
    ds_write_b16 v208, v35 offset:10240
    ds_write_b16_d16_hi v208, v35 offset:11264
    v_cvt_pk_bf16_f32 v36, v200, v201
    v_cvt_pk_bf16_f32 v37, v202, v203
    ds_write_b16 v208, v36 offset:16384
    ds_write_b16_d16_hi v208, v36 offset:17408
    ds_write_b16 v208, v37 offset:18432
    ds_write_b16_d16_hi v208, v37 offset:19456
    v_cvt_pk_bf16_f32 v38, v204, v205
    v_cvt_pk_bf16_f32 v39, v206, v207
    ds_write_b16 v208, v38 offset:24576
    ds_write_b16_d16_hi v208, v38 offset:25600
    ds_write_b16 v208, v39 offset:26624
    ds_write_b16_d16_hi v208, v39 offset:27648
    s_waitcnt lgkmcnt(0)
    ds_add_u32 v31, v29 offset:8
    v_add_f32 v14, v192, v193
    v_add_f32 v15, v194, v195
    v_add_f32 v14, v14, v196
    v_add_f32 v15, v15, v197
    v_add_f32 v14, v14, v198
    v_add_f32 v15, v15, v199
    v_add_f32 v14, v14, v200
    v_add_f32 v15, v15, v201
    v_add_f32 v14, v14, v202
    v_add_f32 v15, v15, v203
    v_add_f32 v14, v14, v204
    v_add_f32 v15, v15, v205
    v_add_f32 v14, v14, v206
    v_add_f32 v15, v15, v207
    v_add_f32 v14, v14, v15
    ds_write_b32 v11, v14 offset:128
    s_waitcnt lgkmcnt(0)
    ds_add_u32 v31, v29 offset:12
    s_cmp_eq_u32 s3, 0
    s_cbranch_scc0 L_if_13
    s_mov_b32 s93, 1600000
L_lw_14:
    ds_read_b32 v30, v28 offset:12
    s_waitcnt lgkmcnt(0)
    v_cmp_gt_u32 vcc, 4, v30
    s_cbranch_vccz L_pd_15
    s_sub_u32 s93, s93, 1
    s_cmp_gt_i32 s93, 0
    s_cbranch_scc1 L_lw_14
L_pd_15:
    ds_read_b128 v[32:35], v10 offset:128
    ds_read_b128 v[36:39], v10 offset:144
    ds_read_b128 v[40:43], v10 offset:160
    ds_read_b128 v[44:47], v10 offset:176
    s_waitcnt lgkmcnt(0)
    v_add_f32 v32, v32, v40
    v_add_f32 v33, v33, v41
    v_add_f32 v34, v34, v42
    v_add_f32 v35, v35, v43
    v_add_f32 v36, v36, v44
    v_add_f32 v37, v37, v45
    v_add_f32 v38, v38, v46
    v_add_f32 v39, v39, v47
    v_add_f32 v32, v32, v36
    v_add_f32 v33, v33, v37
    v_add_f32 v34, v34, v38
    v_add_f32 v35, v35, v39
    v_add_f32 v32, v32, v34
    v_add_f32 v33, v33, v35
    v_add_f32 v49, v32, v33
    s_cbranch_execz L_nm_16
    buffer_store_dwordx2 v[48:49], v13, s[4:7], 0 offen sc1
L_nm_16:
L_if_13:
    s_cbranch_execnz L_AK_done
L_AK_mid:
    s_mov_b64 exec, -1
    s_waitcnt vmcnt(0)
    ds_read_b128 v[64:67], v4 offset:0
    ds_read_b128 v[68:71], v5 offset:0
    ds_read_b128 v[72:75], v6 offset:0
    ds_read_b128 v[76:79], v7 offset:0
    ds_read_b128 v[80:83], v4 offset:256
    ds_read_b128 v[84:87], v5 offset:256
    ds_read_b128 v[88:91], v6 offset:256
    ds_read_b128 v[92:95], v7 offset:256
    ds_read_b128 v[96:99], v4 offset:8192
    ds_read_b128 v[100:103], v5 offset:8192
    ds_read_b128 v[104:107], v6 offset:8192
    ds_read_b128 v[108:111], v7 offset:8192
    ds_read_b128 v[112:115], v4 offset:8448
    ds_read_b128 v[116:119], v5 offset:8448
    ds_read_b128 v[120:123], v6 offset:8448
    ds_read_b128 v[124:127], v7 offset:8448
    ds_read_b128 v[128:131], v4 offset:16384
    ds_read_b128 v[132:135], v5 offset:16384
    ds_read_b128 v[136:139], v6 offset:16384
    ds_read_b128 v[140:143], v7 offset:16384
    ds_read_b128 v[144:147], v4 offset:16640
    ds_read_b128 v[148:151], v5 offset:16640
    ds_read_b128 v[152:155], v6 offset:16640
    ds_read_b128 v[156:159], v7 offset:16640
    ds_read_b128 v[160:163], v4 offset:24576
    ds_read_b128 v[164:167], v5 offset:24576
    ds_read_b128 v[168:171], v6 offset:24576
    ds_read_b128 v[172:175], v7 offset:24576
    ds_read_b128 v[176:179], v4 offset:24832
    ds_read_b128 v[180:183], v5 offset:24832
    ds_read_b128 v[184:187], v6 offset:24832
    ds_read_b128 v[188:191], v7 offset:24832
    s_waitcnt lgkmcnt(0)
    ds_write_b128 v12, v[212:215] offset:0
    ds_write_b128 v12, v[212:215] offset:1024
    ds_write_b128 v12, v[212:215] offset:2048
    ds_write_b128 v12, v[212:215] offset:3072
    ds_write_b128 v12, v[212:215] offset:8192
    ds_write_b128 v12, v[212:215] offset:9216
    ds_write_b128 v12, v[212:215] offset:10240
    ds_write_b128 v12, v[212:215] offset:11264
    ds_write_b128 v12, v[212:215] offset:16384
    ds_write_b128 v12, v[212:215] offset:17408
    ds_write_b128 v12, v[212:215] offset:18432
    ds_write_b128 v12, v[212:215] offset:19456
    ds_write_b128 v12, v[212:215] offset:24576
    ds_write_b128 v12, v[212:215] offset:25600
    ds_write_b128 v12, v[212:215] offset:26624
    ds_write_b128 v12, v[212:215] offset:27648
    s_branch L_AK_top
L_AK_done:
    s_endpgm
L_A_other:
    s_waitcnt lgkmcnt(0)
L_A_other2:
    s_mov_b32 s4, s88
    s_and_b32 s5, s89, 0xffff
    s_mov_b32 s6, 268435456
    s_mov_b32 s7, 0x20000
    s_cmp_ge_u32 s3, 6
    s_cbranch_scc1 L_A_poll
    s_mov_b32 s8, s68
    s_and_b32 s9, s69, 0xffff
    s_mov_b32 s10, 67108864
    s_mov_b32 s11, 0x20000
    s_sub_u32 s30, s3, 4
    s_lshl_b32 s31, s30, 8
    s_add_u32 s28, s28, s31
    v_lshlrev_b32 v3, 11, v2
    v_lshl_add_u32 v3, v1, 4, v3
    v_lshlrev_b32 v4, 4, v0
    v_add_u32 v7, 65536, v4
    v_mov_b32 v12, 132352
    s_lshr_b32 s34, s26, 3
    s_and_b32 s35, s26, 7
    s_lshl_b32 s35, s35, 9
    s_lshl_b32 s31, s30, 7
    s_add_u32 s35, s35, s31
    v_lshrrev_b32 v5, 1, v2
    v_lshlrev_b32 v5, 8, v5
    v_lshl_add_u32 v5, v1, 3, v5
    v_and_b32 v6, 1, v2
    v_lshl_add_u32 v5, v6, 2, v5
    v_add_u32 v5, s35, v5
    v_lshrrev_b32 v6, 6, v5
    v_and_b32 v5, 63, v5
    v_lshlrev_b32 v6, 1, v6
    v_add_u32 v6, s34, v6
    v_mul_u32_u24 v6, 10, v6
    v_add_u32 v6, s27, v6
    v_mul_u32_u24 v6, 64, v6
    v_add_u32 v5, v5, v6
    v_lshlrev_b32 v5, 2, v5
    v_add_u32 v5, 524288, v5
    s_mov_b64 exec, 0
L_AV_top:
    v_mov_b32 v8, 0
    v_mov_b32 v9, 0
    v_mov_b32 v10, 0
    v_mov_b32 v11, 0
    s_mov_b32 s93, 1600000
L_lw_17:
    ds_read_b32 v13, v12 offset:8
    s_waitcnt lgkmcnt(0)
    v_cmp_gt_u32 vcc, 4, v13
    s_cbranch_vccz L_pd_18
    s_sub_u32 s93, s93, 1
    s_cmp_gt_i32 s93, 0
    s_cbranch_scc1 L_lw_17
L_pd_18:
    s_cmp_eq_u32 s29, 12
    s_cbranch_scc0 L_if_21
    ds_read_b128 v[32:35], v7 offset:49152
    ds_read_b128 v[36:39], v7 offset:50176
    ds_read_b128 v[40:43], v7 offset:51200
    ds_read_b128 v[44:47], v7 offset:52224
    s_branch L_pv_20
L_if_21:
    ds_read_b128 v[16:19], v4 offset:24576
    ds_read_b128 v[20:23], v4 offset:25600
    ds_read_b128 v[24:27], v4 offset:26624
    ds_read_b128 v[28:31], v4 offset:27648
L_pv_19:
    ds_read_b128 v[32:35], v7 offset:49152
    ds_read_b128 v[36:39], v7 offset:50176
    ds_read_b128 v[40:43], v7 offset:51200
    ds_read_b128 v[44:47], v7 offset:52224
    s_waitcnt lgkmcnt(4)
    v_mfma_f32_16x16x32_bf16 v[8:11], v[16:19], v[240:243], v[8:11]
    v_mfma_f32_16x16x32_bf16 v[8:11], v[20:23], v[244:247], v[8:11]
    v_mfma_f32_16x16x32_bf16 v[8:11], v[24:27], v[248:251], v[8:11]
    v_mfma_f32_16x16x32_bf16 v[8:11], v[28:31], v[252:255], v[8:11]
L_pv_20:
    ds_read_b128 v[16:19], v7 offset:16384
    ds_read_b128 v[20:23], v7 offset:17408
    ds_read_b128 v[24:27], v7 offset:18432
    ds_read_b128 v[28:31], v7 offset:19456
    s_waitcnt lgkmcnt(4)
    v_mfma_f32_16x16x32_bf16 v[8:11], v[32:35], v[224:227], v[8:11]
    v_mfma_f32_16x16x32_bf16 v[8:11], v[36:39], v[228:231], v[8:11]
    v_mfma_f32_16x16x32_bf16 v[8:11], v[40:43], v[232:235], v[8:11]
    v_mfma_f32_16x16x32_bf16 v[8:11], v[44:47], v[236:239], v[8:11]
    ds_read_b128 v[32:35], v4 offset:49152
    ds_read_b128 v[36:39], v4 offset:50176
    ds_read_b128 v[40:43], v4 offset:51200
    ds_read_b128 v[44:47], v4 offset:52224
    s_waitcnt lgkmcnt(4)
    v_mfma_f32_16x16x32_bf16 v[8:11], v[16:19], v[208:211], v[8:11]
    v_mfma_f32_16x16x32_bf16 v[8:11], v[20:23], v[212:215], v[8:11]
    v_mfma_f32_16x16x32_bf16 v[8:11], v[24:27], v[216:219], v[8:11]
    v_mfma_f32_16x16x32_bf16 v[8:11], v[28:31], v[220:223], v[8:11]
    ds_read_b128 v[16:19], v4 offset:16384
    ds_read_b128 v[20:23], v4 offset:17408
    ds_read_b128 v[24:27], v4 offset:18432
    ds_read_b128 v[28:31], v4 offset:19456
    s_waitcnt lgkmcnt(4)
    v_mfma_f32_16x16x32_bf16 v[8:11], v[32:35], v[192:195], v[8:11]
    v_mfma_f32_16x16x32_bf16 v[8:11], v[36:39], v[196:199], v[8:11]
    v_mfma_f32_16x16x32_bf16 v[8:11], v[40:43], v[200:203], v[8:11]
    v_mfma_f32_16x16x32_bf16 v[8:11], v[44:47], v[204:207], v[8:11]
    ds_read_b128 v[32:35], v7 offset:40960
    ds_read_b128 v[36:39], v7 offset:41984
    ds_read_b128 v[40:43], v7 offset:43008
    ds_read_b128 v[44:47], v7 offset:44032
    s_waitcnt lgkmcnt(4)
    v_mfma_f32_16x16x32_bf16 v[8:11], v[16:19], v[176:179], v[8:11]
    v_mfma_f32_16x16x32_bf16 v[8:11], v[20:23], v[180:183], v[8:11]
    v_mfma_f32_16x16x32_bf16 v[8:11], v[24:27], v[184:187], v[8:11]
    v_mfma_f32_16x16x32_bf16 v[8:11], v[28:31], v[188:191], v[8:11]
    ds_read_b128 v[16:19], v7 offset:8192
    ds_read_b128 v[20:23], v7 offset:9216
    ds_read_b128 v[24:27], v7 offset:10240
    ds_read_b128 v[28:31], v7 offset:11264
    s_waitcnt lgkmcnt(4)
    v_mfma_f32_16x16x32_bf16 v[8:11], v[32:35], v[160:163], v[8:11]
    v_mfma_f32_16x16x32_bf16 v[8:11], v[36:39], v[164:167], v[8:11]
    v_mfma_f32_16x16x32_bf16 v[8:11], v[40:43], v[168:171], v[8:11]
    v_mfma_f32_16x16x32_bf16 v[8:11], v[44:47], v[172:175], v[8:11]
    ds_read_b128 v[32:35], v4 offset:40960
    ds_read_b128 v[36:39], v4 offset:41984
    ds_read_b128 v[40:43], v4 offset:43008
    ds_read_b128 v[44:47], v4 offset:44032
    s_waitcnt lgkmcnt(4)
    v_mfma_f32_16x16x32_bf16 v[8:11], v[16:19], v[144:147], v[8:11]
    v_mfma_f32_16x16x32_bf16 v[8:11], v[20:23], v[148:151], v[8:11]
    v_mfma_f32_16x16x32_bf16 v[8:11], v[24:27], v[152:155], v[8:11]
    v_mfma_f32_16x16x32_bf16 v[8:11], v[28:31], v[156:159], v[8:11]
    ds_read_b128 v[16:19], v4 offset:8192
    ds_read_b128 v[20:23], v4 offset:9216
    ds_read_b128 v[24:27], v4 offset:10240
    ds_read_b128 v[28:31], v4 offset:11264
    s_waitcnt lgkmcnt(4)
    v_mfma_f32_16x16x32_bf16 v[8:11], v[32:35], v[128:131], v[8:11]
    v_mfma_f32_16x16x32_bf16 v[8:11], v[36:39], v[132:135], v[8:11]
    v_mfma_f32_16x16x32_bf16 v[8:11], v[40:43], v[136:139], v[8:11]
    v_mfma_f32_16x16x32_bf16 v[8:11], v[44:47], v[140:143], v[8:11]
    ds_read_b128 v[32:35], v7 offset:32768
    ds_read_b128 v[36:39], v7 offset:33792
    ds_read_b128 v[40:43], v7 offset:34816
    ds_read_b128 v[44:47], v7 offset:35840
    s_waitcnt lgkmcnt(4)
    v_mfma_f32_16x16x32_bf16 v[8:11], v[16:19], v[112:115], v[8:11]
    v_mfma_f32_16x16x32_bf16 v[8:11], v[20:23], v[116:119], v[8:11]
    v_mfma_f32_16x16x32_bf16 v[8:11], v[24:27], v[120:123], v[8:11]
    v_mfma_f32_16x16x32_bf16 v[8:11], v[28:31], v[124:127], v[8:11]
    ds_read_b128 v[16:19], v7 offset:0
    ds_read_b128 v[20:23], v7 offset:1024
    ds_read_b128 v[24:27], v7 offset:2048
    ds_read_b128 v[28:31], v7 offset:3072
    s_waitcnt vmcnt(15) lgkmcnt(7)
    v_mfma_f32_16x16x32_bf16 v[8:11], v[32:35], v[96:99], v[8:11]
    s_waitcnt vmcnt(14) lgkmcnt(6)
    v_mfma_f32_16x16x32_bf16 v[8:11], v[36:39], v[100:103], v[8:11]
    s_waitcnt vmcnt(13) lgkmcnt(5)
    v_mfma_f32_16x16x32_bf16 v[8:11], v[40:43], v[104:107], v[8:11]
    s_waitcnt vmcnt(12) lgkmcnt(4)
    v_mfma_f32_16x16x32_bf16 v[8:11], v[44:47], v[108:111], v[8:11]
    ds_read_b128 v[32:35], v4 offset:32768
    ds_read_b128 v[36:39], v4 offset:33792
    ds_read_b128 v[40:43], v4 offset:34816
    ds_read_b128 v[44:47], v4 offset:35840
    s_waitcnt vmcnt(11) lgkmcnt(7)
    v_mfma_f32_16x16x32_bf16 v[8:11], v[16:19], v[80:83], v[8:11]
    s_waitcnt vmcnt(10) lgkmcnt(6)
    v_mfma_f32_16x16x32_bf16 v[8:11], v[20:23], v[84:87], v[8:11]
    s_waitcnt vmcnt(9) lgkmcnt(5)
    v_mfma_f32_16x16x32_bf16 v[8:11], v[24:27], v[88:91], v[8:11]
    s_waitcnt vmcnt(8) lgkmcnt(4)
    v_mfma_f32_16x16x32_bf16 v[8:11], v[28:31], v[92:95], v[8:11]
    ds_read_b128 v[16:19], v4 offset:0
    ds_read_b128 v[20:23], v4 offset:1024
    ds_read_b128 v[24:27], v4 offset:2048
    ds_read_b128 v[28:31], v4 offset:3072
    s_waitcnt vmcnt(7) lgkmcnt(7)
    v_mfma_f32_16x16x32_bf16 v[8:11], v[32:35], v[64:67], v[8:11]
    s_waitcnt vmcnt(6) lgkmcnt(6)
    v_mfma_f32_16x16x32_bf16 v[8:11], v[36:39], v[68:71], v[8:11]
    s_waitcnt vmcnt(5) lgkmcnt(5)
    v_mfma_f32_16x16x32_bf16 v[8:11], v[40:43], v[72:75], v[8:11]
    s_waitcnt vmcnt(4) lgkmcnt(4)
    v_mfma_f32_16x16x32_bf16 v[8:11], v[44:47], v[76:79], v[8:11]
    s_waitcnt vmcnt(3) lgkmcnt(3)
    v_mfma_f32_16x16x32_bf16 v[8:11], v[16:19], v[48:51], v[8:11]
    s_waitcnt vmcnt(2) lgkmcnt(2)
    v_mfma_f32_16x16x32_bf16 v[8:11], v[20:23], v[52:55], v[8:11]
    s_waitcnt vmcnt(1) lgkmcnt(1)
    v_mfma_f32_16x16x32_bf16 v[8:11], v[24:27], v[56:59], v[8:11]
    s_waitcnt vmcnt(0) lgkmcnt(0)
    v_mfma_f32_16x16x32_bf16 v[8:11], v[28:31], v[60:63], v[8:11]
    s_nop 7
    s_cbranch_execz L_nm_22
    buffer_store_dwordx4 v[8:11], v5, s[4:7], 0 offen sc1
L_nm_22:
    s_cbranch_execnz L_AV_done
L_AV_mid:
    s_mov_b64 exec, -1
    s_barrier
L_AV_post:
    s_cmp_le_u32 s29, 12
    s_cbranch_scc1 L_vskip_23
    s_add_u32 s32, s28, 98304
    buffer_load_dwordx4 v[240:243], v3, s[8:11], s32 offen offset:0 nt
    buffer_load_dwordx4 v[244:247], v3, s[8:11], s32 offen offset:512 nt
    buffer_load_dwordx4 v[248:251], v3, s[8:11], s32 offen offset:1024 nt
    buffer_load_dwordx4 v[252:255], v3, s[8:11], s32 offen offset:1536 nt
L_vskip_23:
    s_add_u32 s32, s28, 90112
    buffer_load_dwordx4 v[224:227], v3, s[8:11], s32 offen offset:0 nt
    buffer_load_dwordx4 v[228:231], v3, s[8:11], s32 offen offset:512 nt
    buffer_load_dwordx4 v[232:235], v3, s[8:11], s32 offen offset:1024 nt
    buffer_load_dwordx4 v[236:239], v3, s[8:11], s32 offen offset:1536 nt
    s_add_u32 s32, s28, 81920
    buffer_load_dwordx4 v[208:211], v3, s[8:11], s32 offen offset:0 nt
    buffer_load_dwordx4 v[212:215], v3, s[8:11], s32 offen offset:512 nt
    buffer_load_dwordx4 v[216:219], v3, s[8:11], s32 offen offset:1024 nt
    buffer_load_dwordx4 v[220:223], v3, s[8:11], s32 offen offset:1536 nt
    s_add_u32 s32, s28, 73728
    buffer_load_dwordx4 v[192:195], v3, s[8:11], s32 offen offset:0 nt
    buffer_load_dwordx4 v[196:199], v3, s[8:11], s32 offen offset:512 nt
    buffer_load_dwordx4 v[200:203], v3, s[8:11], s32 offen offset:1024 nt
    buffer_load_dwordx4 v[204:207], v3, s[8:11], s32 offen offset:1536 nt
    s_add_u32 s32, s28, 65536
    s_waitcnt vmcnt(15)
    buffer_load_dwordx4 v[176:179], v3, s[8:11], s32 offen offset:0 nt
    s_waitcnt vmcnt(15)
    buffer_load_dwordx4 v[180:183], v3, s[8:11], s32 offen offset:512 nt
    s_waitcnt vmcnt(15)
    buffer_load_dwordx4 v[184:187], v3, s[8:11], s32 offen offset:1024 nt
    s_waitcnt vmcnt(15)
    buffer_load_dwordx4 v[188:191], v3, s[8:11], s32 offen offset:1536 nt
    s_add_u32 s32, s28, 57344
    s_waitcnt vmcnt(15)
    buffer_load_dwordx4 v[160:163], v3, s[8:11], s32 offen offset:0 nt
    s_waitcnt vmcnt(15)
    buffer_load_dwordx4 v[164:167], v3, s[8:11], s32 offen offset:512 nt
    s_waitcnt vmcnt(15)
    buffer_load_dwordx4 v[168:171], v3, s[8:11], s32 offen offset:1024 nt
    s_waitcnt vmcnt(15)
    buffer_load_dwordx4 v[172:175], v3, s[8:11], s32 offen offset:1536 nt
    s_add_u32 s32, s28, 49152
    s_waitcnt vmcnt(15)
    buffer_load_dwordx4 v[144:147], v3, s[8:11], s32 offen offset:0 nt
    s_waitcnt vmcnt(15)
    buffer_load_dwordx4 v[148:151], v3, s[8:11], s32 offen offset:512 nt
    s_waitcnt vmcnt(15)
    buffer_load_dwordx4 v[152:155], v3, s[8:11], s32 offen offset:1024 nt
    s_waitcnt vmcnt(15)
    buffer_load_dwordx4 v[156:159], v3, s[8:11], s32 offen offset:1536 nt
    s_add_u32 s32, s28, 40960
    s_waitcnt vmcnt(15)
    buffer_load_dwordx4 v[128:131], v3, s[8:11], s32 offen offset:0 nt
    s_waitcnt vmcnt(15)
    buffer_load_dwordx4 v[132:135], v3, s[8:11], s32 offen offset:512 nt
    s_waitcnt vmcnt(15)
    buffer_load_dwordx4 v[136:139], v3, s[8:11], s32 offen offset:1024 nt
    s_waitcnt vmcnt(15)
    buffer_load_dwordx4 v[140:143], v3, s[8:11], s32 offen offset:1536 nt
    s_add_u32 s32, s28, 32768
    s_waitcnt vmcnt(15)
    buffer_load_dwordx4 v[112:115], v3, s[8:11], s32 offen offset:0 nt
    s_waitcnt vmcnt(15)
    buffer_load_dwordx4 v[116:119], v3, s[8:11], s32 offen offset:512 nt
    s_waitcnt vmcnt(15)
    buffer_load_dwordx4 v[120:123], v3, s[8:11], s32 offen offset:1024 nt
    s_waitcnt vmcnt(15)
    buffer_load_dwordx4 v[124:127], v3, s[8:11], s32 offen offset:1536 nt
    s_add_u32 s32, s28, 24576
    s_waitcnt vmcnt(15)
    buffer_load_dwordx4 v[96:99], v3, s[8:11], s32 offen offset:0 nt
    s_waitcnt vmcnt(15)
    buffer_load_dwordx4 v[100:103], v3, s[8:11], s32 offen offset:512 nt
    s_waitcnt vmcnt(15)
    buffer_load_dwordx4 v[104:107], v3, s[8:11], s32 offen offset:1024 nt
    s_waitcnt vmcnt(15)
    buffer_load_dwordx4 v[108:111], v3, s[8:11], s32 offen offset:1536 nt
    s_add_u32 s32, s28, 16384
    s_waitcnt vmcnt(15)
    buffer_load_dwordx4 v[80:83], v3, s[8:11], s32 offen offset:0 nt
    s_waitcnt vmcnt(15)
    buffer_load_dwordx4 v[84:87], v3, s[8:11], s32 offen offset:512 nt
    s_waitcnt vmcnt(15)
    buffer_load_dwordx4 v[88:91], v3, s[8:11], s32 offen offset:1024 nt
    s_waitcnt vmcnt(15)
    buffer_load_dwordx4 v[92:95], v3, s[8:11], s32 offen offset:1536 nt
    s_add_u32 s32, s28, 8192
    s_waitcnt vmcnt(15)
    buffer_load_dwordx4 v[64:67], v3, s[8:11], s32 offen offset:0 nt
    s_waitcnt vmcnt(15)
    buffer_load_dwordx4 v[68:71], v3, s[8:11], s32 offen offset:512 nt
    s_waitcnt vmcnt(15)
    buffer_load_dwordx4 v[72:75], v3, s[8:11], s32 offen offset:1024 nt
    s_waitcnt vmcnt(15)
    buffer_load_dwordx4 v[76:79], v3, s[8:11], s32 offen offset:1536 nt
    s_add_u32 s32, s28, 0
    s_waitcnt vmcnt(15)
    buffer_load_dwordx4 v[48:51], v3, s[8:11], s32 offen offset:0 nt
    s_waitcnt vmcnt(15)
    buffer_load_dwordx4 v[52:55], v3, s[8:11], s32 offen offset:512 nt
    s_waitcnt vmcnt(15)
    buffer_load_dwordx4 v[56:59], v3, s[8:11], s32 offen offset:1024 nt
    s_waitcnt vmcnt(15)
    buffer_load_dwordx4 v[60:63], v3, s[8:11], s32 offen offset:1536 nt
    s_branch L_AV_top
L_AV_done:
    s_endpgm
L_A_poll:
    s_cmp_lg_u32 s3, 6
    s_cbranch_scc1 L_exit
    s_load_dword s92, s[88:89], 0
    s_waitcnt lgkmcnt(0)
    s_add_u32 s92, s92, 1
    s_and_b32 s91, s92, 0x7f
    s_or_b32 s91, s91, 0x80
    s_lshl_b32 s90, s92, 1
    s_and_b32 s90, s90, 0x7f00
    s_or_b32 s90, s90, 0x8000
    s_or_b32 s90, s90, s91
    s_lshl_b32 s30, s26, 11
    s_add_u32 s30, s30, 1048576
    v_lshlrev_b32 v3, 4, v0
    v_lshlrev_b32 v4, 3, v0
    v_add_u32 v4, 131072, v4
    v_mov_b32 v12, 132352
    v_mov_b32 v13, 1
    v_mov_b32 v5, s91
    s_add_u32 s31, s30, 32768
    v_mov_b32 v8, 0
    v_mov_b32 v9, 0
    v_mov_b32 v10, 0
    v_mov_b32 v11, 0
    ds_write_b128 v12, v[8:11]
    s_waitcnt lgkmcnt(0)
    s_barrier
    s_mov_b32 s93, 200000
    buffer_load_dwordx4 v[16:19], v3, s[4:7], s30 offen sc1
    buffer_load_dwordx4 v[20:23], v3, s[4:7], s30 offen offset:1024 sc1
    buffer_load_dwordx4 v[24:27], v3, s[4:7], s31 offen sc1
    buffer_load_dwordx4 v[28:31], v3, s[4:7], s31 offen offset:1024 sc1
    s_sleep 8
L_qpoll:
    buffer_load_dwordx4 v[32:35], v3, s[4:7], s30 offen sc1
    buffer_load_dwordx4 v[36:39], v3, s[4:7], s30 offen offset:1024 sc1
    buffer_load_dwordx4 v[40:43], v3, s[4:7], s31 offen sc1
    buffer_load_dwordx4 v[44:47], v3, s[4:7], s31 offen offset:1024 sc1
    s_waitcnt vmcnt(4)
    v_msad_u8 v6, v16, v5, 0
    v_msad_u8 v7, v17, v5, 0
    v_msad_u8 v6, v18, v5, v6
    v_msad_u8 v7, v19, v5, v7
    v_msad_u8 v6, v20, v5, v6
    v_msad_u8 v7, v21, v5, v7
    v_msad_u8 v6, v22, v5, v6
    v_msad_u8 v7, v23, v5, v7
    v_msad_u8 v6, v24, v5, v6
    v_msad_u8 v7, v25, v5, v7
    v_msad_u8 v6, v26, v5, v6
    v_msad_u8 v7, v27, v5, v7
    v_msad_u8 v6, v28, v5, v6
    v_msad_u8 v7, v29, v5, v7
    v_msad_u8 v6, v30, v5, v6
    v_msad_u8 v7, v31, v5, v7
    v_or_b32 v6, v6, v7
    v_cmp_ne_u32 vcc, 0, v6
    s_cbranch_vccz L_qgot0
    s_sleep 5
    buffer_load_dwordx4 v[16:19], v3, s[4:7], s30 offen sc1
    buffer_load_dwordx4 v[20:23], v3, s[4:7], s30 offen offset:1024 sc1
    buffer_load_dwordx4 v[24:27], v3, s[4:7], s31 offen sc1
    buffer_load_dwordx4 v[28:31], v3, s[4:7], s31 offen offset:1024 sc1
    s_waitcnt vmcnt(4)
    v_msad_u8 v6, v32, v5, 0
    v_msad_u8 v7, v33, v5, 0
    v_msad_u8 v6, v34, v5, v6
    v_msad_u8 v7, v35, v5, v7
    v_msad_u8 v6, v36, v5, v6
    v_msad_u8 v7, v37, v5, v7
    v_msad_u8 v6, v38, v5, v6
    v_msad_u8 v7, v39, v5, v7
    v_msad_u8 v6, v40, v5, v6
    v_msad_u8 v7, v41, v5, v7
    v_msad_u8 v6, v42, v5, v6
    v_msad_u8 v7, v43, v5, v7
    v_msad_u8 v6, v44, v5, v6
    v_msad_u8 v7, v45, v5, v7
    v_msad_u8 v6, v46, v5, v6
    v_msad_u8 v7, v47, v5, v7
    v_or_b32 v6, v6, v7
    v_cmp_ne_u32 vcc, 0, v6
    s_cbranch_vccz L_qgot1
    s_sleep 5
    s_sub_u32 s93, s93, 1
    s_cbranch_scc0 L_qpoll
L_qgot0:
    v_and_b32 v16, 0xffffff00, v16
    v_and_b32 v17, 0xffffff00, v17
    v_and_b32 v18, 0xffffff00, v18
    v_and_b32 v19, 0xffffff00, v19
    v_and_b32 v20, 0xffffff00, v20
    v_and_b32 v21, 0xffffff00, v21
    v_and_b32 v22, 0xffffff00, v22
    v_and_b32 v23, 0xffffff00, v23
    v_and_b32 v24, 0xffffff00, v24
    v_and_b32 v25, 0xffffff00, v25
    v_and_b32 v26, 0xffffff00, v26
    v_and_b32 v27, 0xffffff00, v27
    v_and_b32 v28, 0xffffff00, v28
    v_and_b32 v29, 0xffffff00, v29
    v_and_b32 v30, 0xffffff00, v30
    v_and_b32 v31, 0xffffff00, v31
    v_pk_add_f32 v[16:17], v[16:17], v[24:25]
    v_pk_add_f32 v[18:19], v[18:19], v[26:27]
    v_pk_add_f32 v[20:21], v[20:21], v[28:29]
    v_pk_add_f32 v[22:23], v[22:23], v[30:31]
    v_cvt_pk_bf16_f32 v8, v16, v17
    v_cvt_pk_bf16_f32 v9, v18, v19
    v_cvt_pk_bf16_f32 v10, v20, v21
    v_cvt_pk_bf16_f32 v11, v22, v23
    s_branch L_qwr
L_qgot1:
    v_and_b32 v32, 0xffffff00, v32
    v_and_b32 v33, 0xffffff00, v33
    v_and_b32 v34, 0xffffff00, v34
    v_and_b32 v35, 0xffffff00, v35
    v_and_b32 v36, 0xffffff00, v36
    v_and_b32 v37, 0xffffff00, v37
    v_and_b32 v38, 0xffffff00, v38
    v_and_b32 v39, 0xffffff00, v39
    v_and_b32 v40, 0xffffff00, v40
    v_and_b32 v41, 0xffffff00, v41
    v_and_b32 v42, 0xffffff00, v42
    v_and_b32 v43, 0xffffff00, v43
    v_and_b32 v44, 0xffffff00, v44
    v_and_b32 v45, 0xffffff00, v45
    v_and_b32 v46, 0xffffff00, v46
    v_and_b32 v47, 0xffffff00, v47
    v_pk_add_f32 v[32:33], v[32:33], v[40:41]
    v_pk_add_f32 v[34:35], v[34:35], v[42:43]
    v_pk_add_f32 v[36:37], v[36:37], v[44:45]
    v_pk_add_f32 v[38:39], v[38:39], v[46:47]
    v_cvt_pk_bf16_f32 v8, v32, v33
    v_cvt_pk_bf16_f32 v9, v34, v35
    v_cvt_pk_bf16_f32 v10, v36, v37
    v_cvt_pk_bf16_f32 v11, v38, v39
L_qwr:
    ds_write_b64 v4, v[8:9]
    ds_write_b64 v4, v[10:11] offset:512
    s_waitcnt lgkmcnt(0)
    ds_write_b32 v12, v13
    s_endpgm
L_roleQ:
    s_load_dword s92, s[88:89], 0
    v_mov_b32 v29, 0xffffff00
    v_and_b32 v27, 1, v1
    v_lshlrev_b32 v27, 9, v27
    v_lshl_add_u32 v27, v2, 4, v27
    v_add_u32 v27, 131072, v27
    s_lshl_b32 s32, s3, 6
    s_lshl_b32 s31, s37, 9
    s_add_u32 s32, s32, s31
    s_lshl_b32 s31, s38, 15
    s_add_u32 s32, s32, s31
    s_add_u32 s32, s32, 1048576
    v_lshlrev_b32 v26, 14, v1
    v_lshl_add_u32 v26, v2, 4, v26
    v_add_u32 v26, s32, v26
    v_lshrrev_b32 v38, 2, v1
    v_lshl_add_u32 v36, v2, 3, v38
    v_lshlrev_b32 v36, 8, v36
    v_lshlrev_b32 v38, 1, v38
    v_and_b32 v37, 1, v2
    v_lshl_add_u32 v38, v37, 3, v38
    v_bfe_u32 v37, v1, 1, 1
    s_lshl_b32 s32, s3, 1
    v_add_u32 v37, s32, v37
    v_xor_b32 v38, v38, v37
    v_lshl_add_u32 v36, v38, 4, v36
    v_and_b32 v38, 1, v1
    v_lshl_add_u32 v36, v38, 3, v36
    v_add_u32 v36, 65536, v36
    s_mul_i32 s32, s30, 3584
    s_add_u32 s32, s32, 4096
    s_add_u32 s35, s32, 7168
    v_lshlrev_b32 v8, 1, v30
    s_lshl_b32 s34, s30, 9
    v_lshlrev_b32 v10, 1, v28
    v_add_u32 v10, s34, v10
    v_add_u32 v10, 131072, v10
    v_cmp_lt_u32 vcc, 1, v1
    s_nop 1
    v_cndmask_b32 v26, v26, v9, vcc
    s_cmp_ge_u32 s3, 6
    s_cbranch_scc0 L_if_24
    s_waitcnt vmcnt(7)
    v_lshlrev_b32 v48, 16, v16
    v_and_b32 v49, 0xffff0000, v16
    v_lshlrev_b32 v50, 16, v17
    v_and_b32 v51, 0xffff0000, v17
    v_lshlrev_b32 v52, 16, v18
    v_and_b32 v53, 0xffff0000, v18
    v_lshlrev_b32 v54, 16, v19
    v_and_b32 v55, 0xffff0000, v19
    v_add_f32 v32, v48, v49
    v_add_f32 v33, v50, v51
    v_add_f32 v32, v32, v52
    v_add_f32 v33, v33, v53
    v_add_f32 v32, v32, v54
    v_add_f32 v33, v33, v55
    v_add_f32 v32, v32, v33
    s_nop 1
    v_add_f32_dpp v32, v32, v32 row_ror:8 row_mask:0xf bank_mask:0xf
    s_nop 1
    v_add_f32_dpp v32, v32, v32 row_ror:4 row_mask:0xf bank_mask:0xf
    s_nop 1
    v_add_f32_dpp v32, v32, v32 row_ror:2 row_mask:0xf bank_mask:0xf
    s_nop 1
    v_add_f32_dpp v32, v32, v32 row_ror:1 row_mask:0xf bank_mask:0xf
    v_mov_b32 v33, v32
    s_nop 1
    v_permlane16_swap_b32 v32, v33
    s_nop 0
    v_add_f32 v32, v32, v33
    v_mov_b32 v33, v32
    s_nop 1
    v_permlane32_swap_b32 v32, v33
    s_nop 0
    v_add_f32 v32, v32, v33
    v_mul_f32 v32, 0x3b124925, v32
    v_sub_f32 v33, v48, v32
    v_mul_f32 v34, v33, v33
    v_sub_f32 v33, v49, v32
    v_fmac_f32 v34, v33, v33
    v_sub_f32 v33, v50, v32
    v_fmac_f32 v34, v33, v33
    v_sub_f32 v33, v51, v32
    v_fmac_f32 v34, v33, v33
    v_sub_f32 v33, v52, v32
    v_fmac_f32 v34, v33, v33
    v_sub_f32 v33, v53, v32
    v_fmac_f32 v34, v33, v33
    v_sub_f32 v33, v54, v32
    v_fmac_f32 v34, v33, v33
    v_sub_f32 v33, v55, v32
    v_fmac_f32 v34, v33, v33
    v_mul_f32 v34, v34, v39
    s_nop 1
    v_add_f32_dpp v34, v34, v34 row_ror:8 row_mask:0xf bank_mask:0xf
    s_nop 1
    v_add_f32_dpp v34, v34, v34 row_ror:4 row_mask:0xf bank_mask:0xf
    s_nop 1
    v_add_f32_dpp v34, v34, v34 row_ror:2 row_mask:0xf bank_mask:0xf
    s_nop 1
    v_add_f32_dpp v34, v34, v34 row_ror:1 row_mask:0xf bank_mask:0xf
    v_mov_b32 v33, v34
    s_nop 1
    v_permlane16_swap_b32 v34, v33
    s_nop 0
    v_add_f32 v34, v34, v33
    v_mov_b32 v33, v34
    s_nop 1
    v_permlane32_swap_b32 v34, v33
    s_nop 0
    v_add_f32 v34, v34, v33
    v_mul_f32 v34, 0x3b124925, v34
    v_cvt_pk_bf16_f32 v33, v32, v34
    v_lshlrev_b32 v32, 16, v33
    v_and_b32 v34, 0xffff0000, v33
    v_add_f32 v34, 0x3727c5ac, v34
    v_cvt_pk_bf16_f32 v34, v34, v34
    v_and_b32 v34, 0xffff0000, v34
    v_sqrt_f32 v34, v34
    s_nop 0
    v_cvt_pk_bf16_f32 v34, v34, v34
    v_and_b32 v34, 0xffff0000, v34
    v_rcp_f32 v34, v34
    s_nop 0
    v_lshlrev_b32 v16, 16, v20
    v_and_b32 v17, 0xffff0000, v20
    v_lshlrev_b32 v18, 16, v21
    v_and_b32 v19, 0xffff0000, v21
    v_sub_f32 v16, v16, v32
    v_sub_f32 v17, v17, v32
    v_sub_f32 v18, v18, v32
    v_sub_f32 v19, v19, v32
    v_cvt_pk_bf16_f32 v38, v16, v17
    v_lshlrev_b32 v16, 16, v38
    v_and_b32 v17, 0xffff0000, v38
    v_cvt_pk_bf16_f32 v38, v18, v19
    v_lshlrev_b32 v18, 16, v38
    v_and_b32 v19, 0xffff0000, v38
    v_mul_f32 v16, v16, v34
    v_mul_f32 v17, v17, v34
    v_mul_f32 v18, v18, v34
    v_mul_f32 v19, v19, v34
    v_cvt_pk_bf16_f32 v38, v16, v17
    v_lshlrev_b32 v16, 16, v38
    v_and_b32 v17, 0xffff0000, v38
    v_cvt_pk_bf16_f32 v38, v18, v19
    v_lshlrev_b32 v18, 16, v38
    v_and_b32 v19, 0xffff0000, v38
L_if_24:
    s_waitcnt lgkmcnt(0)
    s_add_u32 s92, s92, 1
    s_and_b32 s91, s92, 0x7f
    s_or_b32 s91, s91, 0x80
    s_lshl_b32 s90, s92, 1
    s_and_b32 s90, s90, 0x7f00
    s_or_b32 s90, s90, 0x8000
    s_or_b32 s90, s90, s91
    v_mov_b32 v30, s91
    v_mov_b32 v31, s90
    s_mov_b64 exec, 0
L_Q_top:
    s_cmp_ge_u32 s3, 6
    s_cbranch_scc0 L_if_25
    s_mov_b32 s93, 200000
    s_branch L_x1chk
L_x1poll:
    s_cbranch_execz L_nm_26
    buffer_load_dwordx4 v[40:43], v8, s[4:7], s32 offen sc1
    buffer_load_dwordx4 v[44:47], v8, s[4:7], s32 offen offset:1792 sc1
    buffer_load_dwordx4 v[48:51], v8, s[4:7], s35 offen sc1
    buffer_load_dwordx4 v[52:55], v8, s[4:7], s35 offen offset:1792 sc1
L_nm_26:
L_x1chk:
    s_cbranch_execz L_nm_27
    s_waitcnt vmcnt(0)
L_nm_27:
    v_msad_u8 v32, v40, v30, 0
    v_msad_u8 v33, v41, v30, 0
    v_msad_u8 v32, v42, v30, v32
    v_msad_u8 v33, v43, v30, v33
    v_msad_u8 v32, v44, v30, v32
    v_msad_u8 v33, v45, v30, v33
    v_msad_u8 v32, v46, v30, v32
    v_msad_u8 v33, v47, v30, v33
    v_msad_u8 v32, v48, v30, v32
    v_msad_u8 v33, v49, v30, v33
    v_msad_u8 v32, v50, v30, v32
    v_msad_u8 v33, v51, v30, v33
    v_msad_u8 v32, v52, v30, v32
    v_msad_u8 v33, v53, v30, v33
    v_msad_u8 v32, v54, v30, v32
    v_msad_u8 v33, v55, v30, v33
    v_or_b32 v32, v32, v33
    v_cmp_ne_u32 vcc, 0, v32
    s_cbranch_vccz L_pd_28
    s_sub_u32 s93, s93, 1
    s_cmp_gt_i32 s93, 0
    s_cbranch_scc1 L_x1poll
L_pd_28:
    v_and_b32 v40, 0xffffff00, v40
    v_and_b32 v41, 0xffffff00, v41
    v_and_b32 v42, 0xffffff00, v42
    v_and_b32 v43, 0xffffff00, v43
    v_and_b32 v44, 0xffffff00, v44
    v_and_b32 v45, 0xffffff00, v45
    v_and_b32 v46, 0xffffff00, v46
    v_and_b32 v47, 0xffffff00, v47
    v_and_b32 v48, 0xffffff00, v48
    v_and_b32 v49, 0xffffff00, v49
    v_and_b32 v50, 0xffffff00, v50
    v_and_b32 v51, 0xffffff00, v51
    v_and_b32 v52, 0xffffff00, v52
    v_and_b32 v53, 0xffffff00, v53
    v_and_b32 v54, 0xffffff00, v54
    v_and_b32 v55, 0xffffff00, v55
    v_pk_add_f32 v[40:41], v[40:41], v[48:49]
    v_pk_add_f32 v[42:43], v[42:43], v[50:51]
    v_pk_add_f32 v[44:45], v[44:45], v[52:53]
    v_pk_add_f32 v[46:47], v[46:47], v[54:55]
    v_cvt_pk_bf16_f32 v32, v40, v41
    v_lshlrev_b32 v40, 16, v32
    v_and_b32 v41, 0xffff0000, v32
    v_cvt_pk_bf16_f32 v33, v42, v43
    v_lshlrev_b32 v42, 16, v33
    v_and_b32 v43, 0xffff0000, v33
    v_cvt_pk_bf16_f32 v34, v44, v45
    v_lshlrev_b32 v44, 16, v34
    v_and_b32 v45, 0xffff0000, v34
    v_cvt_pk_bf16_f32 v35, v46, v47
    v_lshlrev_b32 v46, 16, v35
    v_and_b32 v47, 0xffff0000, v35
    v_add_f32 v44, 1.0, v44
    v_add_f32 v45, 1.0, v45
    v_add_f32 v46, 1.0, v46
    v_add_f32 v47, 1.0, v47
    v_cvt_pk_bf16_f32 v34, v44, v45
    v_lshlrev_b32 v44, 16, v34
    v_and_b32 v45, 0xffff0000, v34
    v_cvt_pk_bf16_f32 v35, v46, v47
    v_lshlrev_b32 v46, 16, v35
    v_and_b32 v47, 0xffff0000, v35
    v_mul_f32 v44, v44, v16
    v_mul_f32 v45, v45, v17
    v_mul_f32 v46, v46, v18
    v_mul_f32 v47, v47, v19
    v_cvt_pk_bf16_f32 v34, v44, v45
    v_lshlrev_b32 v44, 16, v34
    v_and_b32 v45, 0xffff0000, v34
    v_cvt_pk_bf16_f32 v35, v46, v47
    v_lshlrev_b32 v46, 16, v35
    v_and_b32 v47, 0xffff0000, v35
    v_add_f32 v40, v40, v44
    v_add_f32 v41, v41, v45
    v_add_f32 v42, v42, v46
    v_add_f32 v43, v43, v47
    v_cvt_pk_bf16_f32 v32, v40, v41
    v_cvt_pk_bf16_f32 v33, v42, v43
    ds_write_b64 v10, v[32:33]
    s_waitcnt lgkmcnt(0)
L_if_25:
    s_cbranch_execz L_nb_29
    s_barrier
L_nb_29:
    ds_read_b128 v[64:67], v27 offset:0
    ds_read_b128 v[68:71], v27 offset:64
    ds_read_b128 v[72:75], v27 offset:128
    ds_read_b128 v[76:79], v27 offset:192
    ds_read_b128 v[80:83], v27 offset:256
    ds_read_b128 v[84:87], v27 offset:320
    ds_read_b128 v[88:91], v27 offset:384
    s_waitcnt lgkmcnt(6)
    v_mfma_f32_16x16x32_bf16 v[32:35], v[128:131], v[64:67], 0
    s_waitcnt lgkmcnt(5)
    v_mfma_f32_16x16x32_bf16 v[32:35], v[132:135], v[68:71], v[32:35]
    s_waitcnt lgkmcnt(4)
    v_mfma_f32_16x16x32_bf16 v[32:35], v[136:139], v[72:75], v[32:35]
    s_waitcnt lgkmcnt(3)
    v_mfma_f32_16x16x32_bf16 v[32:35], v[140:143], v[76:79], v[32:35]
    s_waitcnt lgkmcnt(2)
    v_mfma_f32_16x16x32_bf16 v[32:35], v[144:147], v[80:83], v[32:35]
    s_waitcnt lgkmcnt(1)
    v_mfma_f32_16x16x32_bf16 v[32:35], v[148:151], v[84:87], v[32:35]
    s_waitcnt lgkmcnt(0)
    v_mfma_f32_16x16x32_bf16 v[32:35], v[152:155], v[88:91], v[32:35]
    s_nop 7
    v_add_u32 v32, 0x80, v32
    v_add_u32 v33, 0x80, v33
    v_add_u32 v34, 0x80, v34
    v_add_u32 v35, 0x80, v35
    v_and_or_b32 v32, v32, v29, v30
    v_and_or_b32 v33, v33, v29, v30
    v_and_or_b32 v34, v34, v29, v30
    v_and_or_b32 v35, v35, v29, v30
    s_cbranch_execz L_nm_30
    buffer_store_dwordx4 v[32:35], v26, s[4:7], 0 offen sc1
L_nm_30:
    s_cbranch_execnz L_Q_done
L_Q_mid:
    s_mov_b64 exec, -1
    s_waitcnt vmcnt(0)
    s_cmp_ge_u32 s3, 6
    s_cbranch_scc0 L_if_31
    buffer_load_dwordx4 v[40:43], v8, s[4:7], s32 offen sc1
    buffer_load_dwordx4 v[44:47], v8, s[4:7], s32 offen offset:1792 sc1
    buffer_load_dwordx4 v[48:51], v8, s[4:7], s35 offen sc1
    buffer_load_dwordx4 v[52:55], v8, s[4:7], s35 offen offset:1792 sc1
L_if_31:
    s_barrier
    ds_read_b64_tr_b16 v[128:129], v36 offset:0
    ds_read_b64_tr_b16 v[130:131], v36 offset:1024
    ds_read_b64_tr_b16 v[132:133], v36 offset:8192
    ds_read_b64_tr_b16 v[134:135], v36 offset:9216
    ds_read_b64_tr_b16 v[136:137], v36 offset:16384
    ds_read_b64_tr_b16 v[138:139], v36 offset:17408
    ds_read_b64_tr_b16 v[140:141], v36 offset:24576
    ds_read_b64_tr_b16 v[142:143], v36 offset:25600
    ds_read_b64_tr_b16 v[144:145], v36 offset:32768
    ds_read_b64_tr_b16 v[146:147], v36 offset:33792
    ds_read_b64_tr_b16 v[148:149], v36 offset:40960
    ds_read_b64_tr_b16 v[150:151], v36 offset:41984
    ds_read_b64_tr_b16 v[152:153], v36 offset:49152
    ds_read_b64_tr_b16 v[154:155], v36 offset:50176
    s_waitcnt lgkmcnt(0)
    s_branch L_Q_top
L_Q_done:
L_Q_end:
    s_barrier
    s_mov_b32 s12, s72
    s_and_b32 s13, s73, 0xffff
    s_mov_b32 s14, 3670016
    s_mov_b32 s15, 0x20000
    s_mul_i32 s31, s24, 57344
    s_and_b32 s32, s3, 3
    s_lshl_b32 s32, s32, 1
    v_xor_b32 v24, s32, v0
    v_xor_b32 v25, 8, v24
    v_cmp_gt_u32 vcc, 56, v24
    v_lshlrev_b32 v24, 4, v24
    v_cmp_gt_u32 s[34:35], 56, v25
    v_cndmask_b32 v24, v9, v24, vcc
    v_lshlrev_b32 v25, 4, v25
    s_mul_i32 s32, s3, 896
    v_cndmask_b32 v25, v9, v25, s[34:35]
    s_add_u32 s31, s31, s32
    s_add_u32 m0, s33, 0
    s_add_u32 s32, s31, 0
    buffer_load_dwordx4 v24, s[12:15], s32 offen nt lds
    s_add_u32 m0, s33, 8192
    s_add_u32 s32, s31, 7168
    buffer_load_dwordx4 v25, s[12:15], s32 offen nt lds
    s_add_u32 m0, s33, 16384
    s_add_u32 s32, s31, 14336
    buffer_load_dwordx4 v24, s[12:15], s32 offen nt lds
    s_add_u32 m0, s33, 24576
    s_add_u32 s32, s31, 21504
    buffer_load_dwordx4 v25, s[12:15], s32 offen nt lds
    s_add_u32 m0, s33, 32768
    s_add_u32 s32, s31, 28672
    buffer_load_dwordx4 v24, s[12:15], s32 offen nt lds
    s_add_u32 m0, s33, 40960
    s_add_u32 s32, s31, 35840
    buffer_load_dwordx4 v25, s[12:15], s32 offen nt lds
    s_add_u32 m0, s33, 49152
    s_add_u32 s32, s31, 43008
    buffer_load_dwordx4 v24, s[12:15], s32 offen nt lds
    s_add_u32 m0, s33, 57344
    s_add_u32 s32, s31, 50176
    buffer_load_dwordx4 v25, s[12:15], s32 offen nt lds
    s_mov_b32 s38, 0
    s_mov_b32 s25, s28
    v_mov_b32 v22, v9
    v_mov_b32 v23, v9
    v_bfe_u32 v16, v0, 2, 1
    v_and_b32 v17, 3, v0
    s_branch L_back
L_roleL:
    s_mov_b32 s4, s88
    s_and_b32 s5, s89, 0xffff
    s_mov_b32 s6, 268435456
    s_mov_b32 s7, 0x20000
    s_load_dword s92, s[88:89], 0
    v_mov_b32 v4, -1
    v_mov_b32 v5, -1
    v_mov_b32 v6, -1
    v_mov_b32 v7, -1
    s_lshl_b32 s37, s24, 12
    s_add_u32 s37, s37, 393216
    s_lshl_b32 s36, s24, 13
    s_add_u32 s36, s36, 131072
    s_add_u32 s32, s33, s36
    buffer_store_dwordx4 v[4:7], v3, s[4:7], s32 offen sc1
    v_bfe_u32 v16, v0, 2, 1
    v_and_b32 v17, 3, v0
    v_bfe_u32 v18, v0, 3, 1
    v_lshl_add_u32 v19, v18, 1, v16
    v_lshlrev_b32 v22, 5, v19
    v_lshl_add_u32 v22, v17, 3, v22
    s_lshl_b32 s32, s24, 7
    v_add_u32 v22, s32, v22
    v_lshl_add_u32 v19, v16, 1, v18
    v_lshlrev_b32 v23, 5, v19
    v_lshl_add_u32 v23, v17, 3, v23
    v_add_u32 v23, s32, v23
    v_cmp_lt_u32 vcc, 15, v0
    v_add_u32 v22, 114688, v22
    v_add_u32 v23, 122880, v23
    v_cndmask_b32 v22, v22, v9, vcc
    v_cndmask_b32 v23, v23, v9, vcc
    s_cmp_ge_u32 s3, 4
    s_cbranch_scc0 L_if_32
    s_add_u32 s32, s33, s37
    s_sub_u32 s32, s32, 4096
    buffer_store_dwordx4 v[4:7], v3, s[4:7], s32 offen sc1
L_if_32:
    s_cmp_eq_u32 s3, 7
    s_cbranch_scc0 L_if_33
    buffer_store_dwordx2 v[4:5], v22, s[4:7], 0 offen sc1
    buffer_store_dwordx2 v[4:5], v23, s[4:7], 0 offen sc1
L_if_33:
    s_and_b32 s34, s3, 3
    v_and_b32 v27, 1, v1
    v_lshlrev_b32 v27, 10, v27
    v_lshl_add_u32 v27, v2, 4, v27
    v_add_u32 v27, 138240, v27
    s_mul_i32 s35, s28, 7168
    s_lshl_b32 s32, s29, 8
    s_add_u32 s35, s35, s32
    s_add_u32 s35, s35, 4096
    s_lshl_b32 s32, s24, 9
    s_add_u32 s32, s32, 65536
    s_movk_i32 s31, 3584
    s_cmp_ge_u32 s3, 4
    s_cselect_b32 s35, s32, s35
    s_cselect_b32 s31, 256, s31
    s_lshl_b32 s32, s34, 6
    s_add_u32 s35, s35, s32
    v_mul_u32_u24 v28, s31, v1
    v_lshl_add_u32 v28, v2, 4, v28
    v_add_u32 v28, s35, v28
    s_mul_i32 s32, s28, 448
    v_add_u32 v8, s32, v27
    s_lshl_b32 s31, s30, 10
    s_add_u32 s31, s31, 138240
    v_add_u32 v10, s31, v3
    v_mov_b32 v29, 0xffff0000
    v_mov_b32 v21, 0xffffff00
    v_cmp_lt_u32 vcc, 1, v1
    s_nop 1
    v_cndmask_b32 v28, v28, v9, vcc
    v_lshrrev_b32 v38, 2, v1
    v_lshl_add_u32 v36, v2, 3, v38
    v_lshlrev_b32 v36, 7, v36
    v_and_b32 v38, 2, v38
    v_and_b32 v37, 1, v2
    v_lshl_add_u32 v38, v37, 2, v38
    v_bfe_u32 v37, v1, 1, 1
    s_lshl_b32 s32, s34, 1
    v_add_u32 v37, s32, v37
    v_xor_b32 v38, v38, v37
    v_lshl_add_u32 v36, v38, 4, v36
    v_and_b32 v38, 1, v1
    v_lshl_add_u32 v36, v38, 3, v36
    s_waitcnt lgkmcnt(0)
    s_add_u32 s92, s92, 1
    s_and_b32 s91, s92, 0x7f
    s_or_b32 s91, s91, 0x80
    s_lshl_b32 s90, s92, 1
    s_and_b32 s90, s90, 0x7f00
    s_or_b32 s90, s90, 0x8000
    s_or_b32 s90, s90, s91
    v_mov_b32 v30, s91
    v_mov_b32 v31, s90
    s_cmp_ge_u32 s3, 4
    s_cbranch_scc1 L_Mskip
    s_mov_b64 exec, 0
L_M1_top:
    s_cmp_lt_u32 s3, 2
    s_cbranch_scc0 L_if_34
    s_cbranch_execz L_nm_35
    s_waitcnt vmcnt(5)
L_nm_35:
    v_lshlrev_b32 v40, 16, v12
    v_and_b32 v41, 0xffff0000, v12
    v_lshlrev_b32 v42, 16, v13
    v_and_b32 v43, 0xffff0000, v13
    v_lshlrev_b32 v44, 16, v14
    v_and_b32 v45, 0xffff0000, v14
    v_lshlrev_b32 v46, 16, v15
    v_and_b32 v47, 0xffff0000, v15
    v_mul_f32 v48, 0xbfb8aa3b, v40
    v_mul_f32 v49, 0xbfb8aa3b, v41
    v_mul_f32 v50, 0xbfb8aa3b, v42
    v_mul_f32 v51, 0xbfb8aa3b, v43
    v_mul_f32 v52, 0xbfb8aa3b, v44
    v_mul_f32 v53, 0xbfb8aa3b, v45
    v_mul_f32 v54, 0xbfb8aa3b, v46
    v_mul_f32 v55, 0xbfb8aa3b, v47
    v_exp_f32 v48, v48
    v_exp_f32 v49, v49
    v_exp_f32 v50, v50
    v_exp_f32 v51, v51
    v_exp_f32 v52, v52
    v_exp_f32 v53, v53
    v_exp_f32 v54, v54
    v_exp_f32 v55, v55
    v_add_f32 v48, 1.0, v48
    v_add_f32 v49, 1.0, v49
    v_add_f32 v50, 1.0, v50
    v_add_f32 v51, 1.0, v51
    v_add_f32 v52, 1.0, v52
    v_add_f32 v53, 1.0, v53
    v_add_f32 v54, 1.0, v54
    v_add_f32 v55, 1.0, v55
    v_rcp_f32 v48, v48
    v_rcp_f32 v49, v49
    v_rcp_f32 v50, v50
    v_rcp_f32 v51, v51
    v_rcp_f32 v52, v52
    v_rcp_f32 v53, v53
    v_rcp_f32 v54, v54
    v_rcp_f32 v55, v55
    v_mul_f32 v40, v40, v48
    v_mul_f32 v41, v41, v49
    v_mul_f32 v42, v42, v50
    v_mul_f32 v43, v43, v51
    v_mul_f32 v44, v44, v52
    v_mul_f32 v45, v45, v53
    v_mul_f32 v46, v46, v54
    v_mul_f32 v47, v47, v55
    v_cvt_pk_bf16_f32 v48, v40, v41
    v_cvt_pk_bf16_f32 v49, v42, v43
    v_cvt_pk_bf16_f32 v50, v44, v45
    v_cvt_pk_bf16_f32 v51, v46, v47
    ds_write_b128 v10, v[48:51]
L_if_34:
    s_cbranch_execz L_nm_36
    s_waitcnt vmcnt(1) lgkmcnt(0)
L_nm_36:
    s_cbranch_execz L_nb_37
    s_barrier
L_nb_37:
    ds_read_b64_tr_b16 v[128:129], v36 offset:0
    ds_read_b64_tr_b16 v[130:131], v36 offset:512
    ds_read_b128 v[64:67], v8 offset:0
    ds_read_b64_tr_b16 v[132:133], v36 offset:4096
    ds_read_b64_tr_b16 v[134:135], v36 offset:4608
    ds_read_b128 v[68:71], v8 offset:64
    ds_read_b64_tr_b16 v[136:137], v36 offset:8192
    ds_read_b64_tr_b16 v[138:139], v36 offset:8704
    ds_read_b128 v[72:75], v8 offset:128
    ds_read_b64_tr_b16 v[140:141], v36 offset:12288
    ds_read_b64_tr_b16 v[142:143], v36 offset:12800
    ds_read_b128 v[76:79], v8 offset:192
    ds_read_b64_tr_b16 v[144:145], v36 offset:16384
    ds_read_b64_tr_b16 v[146:147], v36 offset:16896
    ds_read_b128 v[80:83], v8 offset:256
    ds_read_b64_tr_b16 v[148:149], v36 offset:20480
    ds_read_b64_tr_b16 v[150:151], v36 offset:20992
    ds_read_b128 v[84:87], v8 offset:320
    ds_read_b64_tr_b16 v[152:153], v36 offset:24576
    ds_read_b64_tr_b16 v[154:155], v36 offset:25088
    ds_read_b128 v[88:91], v8 offset:384
    s_waitcnt lgkmcnt(15)
    v_mfma_f32_16x16x32_bf16 v[32:35], v[128:131], v[64:67], 0
    s_waitcnt lgkmcnt(15)
    v_mfma_f32_16x16x32_bf16 v[32:35], v[132:135], v[68:71], v[32:35]
    s_waitcnt lgkmcnt(12)
    v_mfma_f32_16x16x32_bf16 v[32:35], v[136:139], v[72:75], v[32:35]
    s_waitcnt lgkmcnt(9)
    v_mfma_f32_16x16x32_bf16 v[32:35], v[140:143], v[76:79], v[32:35]
    s_waitcnt lgkmcnt(6)
    v_mfma_f32_16x16x32_bf16 v[32:35], v[144:147], v[80:83], v[32:35]
    s_waitcnt lgkmcnt(3)
    v_mfma_f32_16x16x32_bf16 v[32:35], v[148:151], v[84:87], v[32:35]
    s_waitcnt lgkmcnt(0)
    v_mfma_f32_16x16x32_bf16 v[32:35], v[152:155], v[88:91], v[32:35]
    s_nop 7
    v_add_u32 v32, 0x80, v32
    v_add_u32 v33, 0x80, v33
    v_add_u32 v34, 0x80, v34
    v_add_u32 v35, 0x80, v35
    v_and_or_b32 v32, v32, v21, v30
    v_and_or_b32 v33, v33, v21, v30
    v_and_or_b32 v34, v34, v21, v30
    v_and_or_b32 v35, v35, v21, v30
    s_cbranch_execz L_nm_38
    buffer_store_dwordx4 v[32:35], v28, s[4:7], 0 offen sc1
L_nm_38:
    s_cbranch_execnz L_M1_done
L_M1_mid:
    s_mov_b64 exec, -1
    s_branch L_M1_top
L_M1_done:
    s_waitcnt vmcnt(1)
    s_branch L_L2
L_Mskip:
    s_waitcnt vmcnt(0)
    s_barrier
L_L2:
    s_getreg_b32 s31, hwreg(HW_REG_XCC_ID, 0, 4)
    s_lshl_b32 s31, s31, 16
    s_or_b32 s31, s31, s90
    v_mov_b32 v56, s31
    v_mov_b32 v57, s31
    v_mov_b32 v58, s31
    v_mov_b32 v59, s31
    s_lshl_b32 s31, s24, 4
    s_add_u32 s31, s31, 20480
    v_mov_b32 v8, s31
    v_cmp_ne_u32 vcc, 0, v0
    s_nop 1
    v_cndmask_b32 v8, v8, v9, vcc
    s_barrier
    s_cmp_eq_u32 s3, 7
    s_cbranch_scc0 L_if_39
    buffer_store_dwordx4 v[56:59], v8, s[4:7], 0 offen sc1
L_if_39:
    s_mov_b32 s16, s76
    s_and_b32 s17, s77, 0xffff
    s_mov_b32 s18, 1605632
    s_mov_b32 s19, 0x20000
    s_mov_b32 s20, s78
    s_and_b32 s21, s79, 0xffff
    s_mov_b32 s22, 1605632
    s_mov_b32 s23, 0x20000
    s_lshl_b32 s35, s24, 7
    s_add_u32 s35, s35, 1792
    s_mul_i32 s32, s3, 43008
    s_add_u32 s35, s35, s32
    s_add_u32 m0, s33, 57344
    s_add_u32 s32, s35, 0
    buffer_load_dwordx4 v25, s[8:11], s32 offen nt lds
    s_add_u32 m0, s33, 65536
    s_add_u32 s32, s35, 344064
    buffer_load_dwordx4 v25, s[8:11], s32 offen nt lds
    s_add_u32 m0, s33, 73728
    s_add_u32 s32, s35, 688128
    buffer_load_dwordx4 v25, s[8:11], s32 offen nt lds
    s_add_u32 m0, s33, 81920
    s_add_u32 s32, s35, 1032192
    buffer_load_dwordx4 v25, s[8:11], s32 offen nt lds
    s_add_u32 m0, s33, 90112
    s_add_u32 s32, s35, 1376256
    buffer_load_dwordx4 v25, s[8:11], s32 offen nt lds
    s_add_u32 m0, s33, 98304
    s_add_u32 s32, s35, 1720320
    buffer_load_dwordx4 v25, s[8:11], s32 offen nt lds
    s_add_u32 m0, s33, 106496
    s_add_u32 s32, s35, 2064384
    buffer_load_dwordx4 v25, s[8:11], s32 offen nt lds
    s_movk_i32 s32, 3584
    v_mul_lo_u32 v24, v24, s32
    v_add_u32 v24, v24, v26
    s_lshl_b32 s35, s24, 7
    s_mul_i32 s32, s3, 28672
    s_add_u32 s35, s35, s32
    s_add_u32 m0, s33, 0
    s_add_u32 s32, s35, 0
    buffer_load_dwordx4 v24, s[16:19], s32 offen nt lds
    s_add_u32 m0, s33, 8192
    s_add_u32 s32, s35, 229376
    buffer_load_dwordx4 v24, s[16:19], s32 offen nt lds
    s_add_u32 m0, s33, 16384
    s_add_u32 s32, s35, 458752
    buffer_load_dwordx4 v24, s[16:19], s32 offen nt lds
    s_add_u32 m0, s33, 24576
    s_add_u32 s32, s35, 688128
    buffer_load_dwordx4 v24, s[16:19], s32 offen nt lds
    s_add_u32 m0, s33, 32768
    s_add_u32 s32, s35, 917504
    buffer_load_dwordx4 v24, s[16:19], s32 offen nt lds
    s_add_u32 m0, s33, 40960
    s_add_u32 s32, s35, 1146880
    buffer_load_dwordx4 v24, s[16:19], s32 offen nt lds
    s_add_u32 m0, s33, 49152
    s_add_u32 s32, s35, 1376256
    buffer_load_dwordx4 v24, s[16:19], s32 offen nt lds
    s_waitcnt vmcnt(7)
    s_barrier
    s_cmp_ge_u32 s3, 4
    s_cbranch_scc0 L_if_40
    v_add_u32 v36, 57344, v36
    ds_read_b64_tr_b16 v[128:129], v36 offset:0
    ds_read_b64_tr_b16 v[130:131], v36 offset:512
    ds_read_b128 v[64:67], v27 offset:0
    ds_read_b64_tr_b16 v[132:133], v36 offset:4096
    ds_read_b64_tr_b16 v[134:135], v36 offset:4608
    ds_read_b128 v[68:71], v27 offset:64
    ds_read_b64_tr_b16 v[136:137], v36 offset:8192
    ds_read_b64_tr_b16 v[138:139], v36 offset:8704
    ds_read_b128 v[72:75], v27 offset:128
    ds_read_b64_tr_b16 v[140:141], v36 offset:12288
    ds_read_b64_tr_b16 v[142:143], v36 offset:12800
    ds_read_b128 v[76:79], v27 offset:192
    ds_read_b64_tr_b16 v[144:145], v36 offset:16384
    ds_read_b64_tr_b16 v[146:147], v36 offset:16896
    ds_read_b128 v[80:83], v27 offset:256
    ds_read_b64_tr_b16 v[148:149], v36 offset:20480
    ds_read_b64_tr_b16 v[150:151], v36 offset:20992
    ds_read_b128 v[84:87], v27 offset:320
    ds_read_b64_tr_b16 v[152:153], v36 offset:24576
    ds_read_b64_tr_b16 v[154:155], v36 offset:25088
    ds_read_b128 v[88:91], v27 offset:384
    ds_read_b64_tr_b16 v[156:157], v36 offset:28672
    ds_read_b64_tr_b16 v[158:159], v36 offset:29184
    ds_read_b128 v[92:95], v27 offset:448
    ds_read_b64_tr_b16 v[160:161], v36 offset:32768
    ds_read_b64_tr_b16 v[162:163], v36 offset:33280
    ds_read_b128 v[96:99], v27 offset:512
    ds_read_b64_tr_b16 v[164:165], v36 offset:36864
    ds_read_b64_tr_b16 v[166:167], v36 offset:37376
    ds_read_b128 v[100:103], v27 offset:576
    ds_read_b64_tr_b16 v[168:169], v36 offset:40960
    ds_read_b64_tr_b16 v[170:171], v36 offset:41472
    ds_read_b128 v[104:107], v27 offset:640
    ds_read_b64_tr_b16 v[172:173], v36 offset:45056
    ds_read_b64_tr_b16 v[174:175], v36 offset:45568
    ds_read_b128 v[108:111], v27 offset:704
    ds_read_b64_tr_b16 v[176:177], v36 offset:49152
    ds_read_b64_tr_b16 v[178:179], v36 offset:49664
    ds_read_b128 v[112:115], v27 offset:768
    ds_read_b64_tr_b16 v[180:181], v36 offset:53248
    ds_read_b64_tr_b16 v[182:183], v36 offset:53760
    ds_read_b128 v[116:119], v27 offset:832
    s_waitcnt lgkmcnt(0)
    v_mfma_f32_16x16x32_bf16 v[32:35], v[128:131], v[64:67], 0
    v_mfma_f32_16x16x32_bf16 v[32:35], v[132:135], v[68:71], v[32:35]
    v_mfma_f32_16x16x32_bf16 v[32:35], v[136:139], v[72:75], v[32:35]
    v_mfma_f32_16x16x32_bf16 v[32:35], v[140:143], v[76:79], v[32:35]
    v_mfma_f32_16x16x32_bf16 v[32:35], v[144:147], v[80:83], v[32:35]
    v_mfma_f32_16x16x32_bf16 v[32:35], v[148:151], v[84:87], v[32:35]
    v_mfma_f32_16x16x32_bf16 v[32:35], v[152:155], v[88:91], v[32:35]
    v_mfma_f32_16x16x32_bf16 v[32:35], v[156:159], v[92:95], v[32:35]
    v_mfma_f32_16x16x32_bf16 v[32:35], v[160:163], v[96:99], v[32:35]
    v_mfma_f32_16x16x32_bf16 v[32:35], v[164:167], v[100:103], v[32:35]
    v_mfma_f32_16x16x32_bf16 v[32:35], v[168:171], v[104:107], v[32:35]
    v_mfma_f32_16x16x32_bf16 v[32:35], v[172:175], v[108:111], v[32:35]
    v_mfma_f32_16x16x32_bf16 v[32:35], v[176:179], v[112:115], v[32:35]
    v_mfma_f32_16x16x32_bf16 v[32:35], v[180:183], v[116:119], v[32:35]
    s_nop 7
    v_cvt_pk_bf16_f32 v37, v32, v33
    v_cvt_pk_bf16_f32 v38, v34, v35
    v_lshl_or_b32 v32, v37, 16, v31
    v_and_or_b32 v33, v37, v29, v31
    v_lshl_or_b32 v34, v38, 16, v31
    v_and_or_b32 v35, v38, v29, v31
    buffer_store_dwordx4 v[32:35], v28, s[4:7], 0 offen sc1
L_if_40:
    s_barrier
    s_mul_i32 s31, s24, 57344
    s_and_b32 s32, s3, 3
    s_lshl_b32 s32, s32, 1
    v_xor_b32 v24, s32, v0
    v_xor_b32 v25, 8, v24
    v_cmp_gt_u32 vcc, 56, v24
    v_lshlrev_b32 v24, 4, v24
    v_cmp_gt_u32 s[34:35], 56, v25
    v_cndmask_b32 v24, v9, v24, vcc
    v_lshlrev_b32 v25, 4, v25
    s_mul_i32 s32, s3, 896
    v_cndmask_b32 v25, v9, v25, s[34:35]
    s_add_u32 s31, s31, s32
    s_add_u32 m0, s33, 57344
    s_add_u32 s32, s31, 0
    buffer_load_dwordx4 v24, s[20:23], s32 offen nt lds
    s_add_u32 m0, s33, 65536
    s_add_u32 s32, s31, 7168
    buffer_load_dwordx4 v25, s[20:23], s32 offen nt lds
    s_add_u32 m0, s33, 73728
    s_add_u32 s32, s31, 14336
    buffer_load_dwordx4 v24, s[20:23], s32 offen nt lds
    s_add_u32 m0, s33, 81920
    s_add_u32 s32, s31, 21504
    buffer_load_dwordx4 v25, s[20:23], s32 offen nt lds
    s_add_u32 m0, s33, 90112
    s_add_u32 s32, s31, 28672
    buffer_load_dwordx4 v24, s[20:23], s32 offen nt lds
    s_add_u32 m0, s33, 98304
    s_add_u32 s32, s31, 35840
    buffer_load_dwordx4 v25, s[20:23], s32 offen nt lds
    s_add_u32 m0, s33, 106496
    s_add_u32 s32, s31, 43008
    buffer_load_dwordx4 v24, s[20:23], s32 offen nt lds
    s_add_u32 m0, s33, 114688
    s_add_u32 s32, s31, 50176
    buffer_load_dwordx4 v25, s[20:23], s32 offen nt lds
    s_mov_b32 s38, 1
    s_mov_b32 s25, 0
    s_mov_b32 s29, 0
L_back:
    s_mov_b32 s8, s84
    s_and_b32 s9, s85, 0xffff
    s_mov_b32 s10, 1792
    s_mov_b32 s11, 0x20000
    s_mov_b32 s12, s64
    s_and_b32 s13, s65, 0xffff
    s_mov_b32 s14, 1792
    s_mov_b32 s15, 0x20000
    s_sub_u32 s30, s3, 5
    s_and_b32 s30, s30, 1
    s_mul_i32 s32, s30, 2560
    s_add_u32 s25, s25, s32
    s_lshl_b32 s32, s30, 7
    s_add_u32 s29, s29, s32
    v_lshlrev_b32 v8, 3, v1
    v_lshlrev_b32 v10, 2, v2
    v_lshlrev_b32 v11, 3, v1
    v_lshl_add_u32 v11, v2, 1, v11
    s_lshl_b32 s34, s30, 7
    v_add_u32 v11, s34, v11
    v_add_u32 v11, 133120, v11
    v_and_b32 v27, 1, v1
    v_lshlrev_b32 v25, 7, v27
    v_lshl_add_u32 v24, v2, 3, v25
    v_lshl_add_u32 v25, v2, 4, v25
    v_add_u32 v25, 133120, v25
    s_and_b32 s34, s3, 3
    s_lshl_b32 s32, s34, 5
    v_add_u32 v24, s32, v24
    v_add_u32 v24, 133120, v24
    v_lshrrev_b32 v26, 1, v1
    v_mov_b32 v32, 140288
    v_cmp_eq_u32 vcc, 0, v26
    s_nop 1
    v_cndmask_b32 v56, v32, v25, vcc
    v_cmp_eq_u32 vcc, 1, v26
    s_nop 1
    v_cndmask_b32 v57, v32, v25, vcc
    v_cmp_eq_u32 vcc, 2, v26
    s_nop 1
    v_cndmask_b32 v58, v32, v25, vcc
    v_cmp_eq_u32 vcc, 3, v26
    s_nop 1
    v_cndmask_b32 v59, v32, v25, vcc
    v_lshl_add_u32 v26, v26, 3, s3
    s_lshl_b32 s32, s38, 12
    s_sub_u32 s32, 8192, s32
    v_mul_lo_u32 v28, v26, s32
    v_lshl_add_u32 v28, v27, 6, v28
    v_lshl_add_u32 v28, v2, 4, v28
    s_lshl_b32 s35, s24, 7
    s_mul_i32 s32, s38, 262144
    s_add_u32 s35, s35, s32
    s_add_u32 s35, s35, 131072
    v_add_u32 v28, s35, v28
    v_cmp_le_u32 vcc, 28, v26
    v_mov_b32 v13, 0
    v_lshl_add_u32 v18, v17, 2, v2
    v_cndmask_b32 v28, v28, v9, vcc
    v_cmp_le_u32 vcc, 32, v0
    v_mul_u32_u24 v15, 448, v16
    v_add_u32 v15, v15, v18
    v_cndmask_b32 v12, v3, v9, vcc
    v_cmp_ne_u32 vcc, 0, v0
    s_lshl_b32 s32, s24, 4
    v_add_u32 v15, s32, v15
    v_cndmask_b32 v13, v13, v9, vcc
    v_lshlrev_b32 v15, 1, v15
    v_and_b32 v19, 0x18, v0
    v_cmp_ne_u32 vcc, 0, v19
    v_bfe_u32 v19, v0, 3, 1
    v_lshl_add_u32 v22, v19, 1, v16
    v_cndmask_b32 v14, v15, v9, vcc
    v_lshlrev_b32 v22, 5, v22
    v_lshl_add_u32 v22, v18, 1, v22
    s_lshl_b32 s32, s24, 7
    s_add_u32 s32, s32, 114688
    v_add_u32 v22, s32, v22
    v_and_b32 v19, 16, v0
    v_cmp_ne_u32 vcc, 0, v19
    v_lshrrev_b32 v29, 1, v2
    v_lshlrev_b32 v29, 7, v29
    v_cndmask_b32 v22, v22, v9, vcc
    v_and_b32 v19, 3, v1
    v_lshl_add_u32 v29, v19, 5, v29
    v_and_b32 v19, 1, v2
    v_lshl_add_u32 v29, v19, 4, v29
    v_add_u32 v29, 140416, v29
    v_lshlrev_b32 v19, 6, v0
    v_add_u32 v19, 122880, v19
    v_cmp_le_u32 vcc, 56, v0
    v_and_b32 v27, 3, v1
    v_lshlrev_b32 v27, 10, v27
    v_cndmask_b32 v19, v19, v9, vcc
    v_cndmask_b32 v39, 1.0, 0, vcc
    v_lshl_add_u32 v27, v2, 4, v27
    v_add_u32 v27, 134144, v27
    v_add_u32 v25, 140416, v3
    v_lshlrev_b32 v26, 3, v0
    v_add_u32 v26, 144512, v26
    s_mov_b32 s94, 0
    s_mov_b32 s62, 0x3d800000
    s_mov_b32 s39, 114688
    v_cmp_le_u32 s[60:61], 8, v1
    v_and_b32 v32, 4, v1
    v_cmp_ne_u32 s[56:57], 0, v32
    v_lshrrev_b32 v32, 2, v1
    v_lshl_add_u32 v24, v32, 1, v24
    v_mov_b32 v32, 0
    v_lshlrev_b32 v33, 2, v0
    v_and_b32 v33, 127, v33
    v_add_u32 v33, 140288, v33
    ds_write_b32 v33, v32
    s_mov_b64 exec, 0
L_T_top:
    s_cmp_eq_u32 s38, 1
    s_cbranch_scc1 L_T_fl
    s_sub_u32 s32, s3, 5
    s_cmp_lt_u32 s32, 2
    s_cbranch_scc0 L_if_41
    s_mov_b32 s93, 200000
L_mlpoll:
    s_cbranch_execz L_nm_42
    buffer_load_dwordx2 v[32:33], v8, s[4:7], s29 offen sc1
    buffer_load_dwordx4 v[40:43], v3, s[4:7], s25 offen offset:0 sc1
    buffer_load_dwordx4 v[44:47], v3, s[4:7], s25 offen offset:1024 sc1
    buffer_load_dwordx4 v[48:51], v12, s[4:7], s25 offen offset:2048 sc1
    s_waitcnt vmcnt(3)
L_nm_42:
    v_cmp_gt_u32 s[34:35], 10, v1
    v_cmp_u_f32 vcc, v32, v33
    s_and_b64 vcc, vcc, s[34:35]
    s_cbranch_vccz L_pd_43
    s_sub_u32 s93, s93, 1
    s_cmp_gt_i32 s93, 0
    s_cbranch_scc1 L_mlpoll
L_pd_43:
    v_mov_b32 v34, 0xff800000
    v_cndmask_b32 v32, v34, v32, s[34:35]
    v_cndmask_b32 v33, 0, v33, s[34:35]
    v_mov_b32 v34, v32
    s_nop 1
    v_max_f32_dpp v34, v34, v34 row_ror:8 row_mask:0xf bank_mask:0xf
    s_nop 1
    v_max_f32_dpp v34, v34, v34 row_ror:4 row_mask:0xf bank_mask:0xf
    s_nop 1
    v_max_f32_dpp v34, v34, v34 row_ror:2 row_mask:0xf bank_mask:0xf
    s_nop 1
    v_max_f32_dpp v34, v34, v34 row_ror:1 row_mask:0xf bank_mask:0xf
    v_sub_f32 v32, v32, v34
    v_exp_f32 v32, v32
    s_nop 0
    v_mul_f32 v33, v33, v32
    s_nop 1
    v_add_f32_dpp v33, v33, v33 row_ror:8 row_mask:0xf bank_mask:0xf
    s_nop 1
    v_add_f32_dpp v33, v33, v33 row_ror:4 row_mask:0xf bank_mask:0xf
    s_nop 1
    v_add_f32_dpp v33, v33, v33 row_ror:2 row_mask:0xf bank_mask:0xf
    s_nop 1
    v_add_f32_dpp v33, v33, v33 row_ror:1 row_mask:0xf bank_mask:0xf
    v_rcp_f32 v33, v33
    s_nop 0
    v_mul_f32 v32, v32, v33
    v_add_u32 v34, 0, v10
    ds_bpermute_b32 v72, v34, v32
    v_add_u32 v34, 16, v10
    ds_bpermute_b32 v73, v34, v32
    v_add_u32 v34, 32, v10
    ds_bpermute_b32 v74, v34, v32
    s_waitcnt lgkmcnt(0)
    s_mov_b32 s93, 200000
    s_branch L_x3chk
L_x3poll:
    s_cbranch_execz L_nm_44
    buffer_load_dwordx4 v[40:43], v3, s[4:7], s25 offen offset:0 sc1
    buffer_load_dwordx4 v[44:47], v3, s[4:7], s25 offen offset:1024 sc1
    buffer_load_dwordx4 v[48:51], v12, s[4:7], s25 offen offset:2048 sc1
L_nm_44:
L_x3chk:
    s_cbranch_execz L_nm_45
    s_waitcnt vmcnt(0)
L_nm_45:
    v_mul_f32 v32, v40, v72
    v_fmac_f32 v32, v44, v73
    v_fmac_f32 v32, v48, v74
    v_cmp_u_f32 vcc, v32, v32
    s_cbranch_vccz L_pd_46
    s_sub_u32 s93, s93, 1
    s_cmp_gt_i32 s93, 0
    s_cbranch_scc1 L_x3poll
L_pd_46:
    v_mul_f32 v33, v41, v72
    v_fmac_f32 v33, v45, v73
    v_fmac_f32 v33, v49, v74
    v_mul_f32 v34, v42, v72
    v_fmac_f32 v34, v46, v73
    v_fmac_f32 v34, v50, v74
    v_mul_f32 v35, v43, v72
    v_fmac_f32 v35, v47, v73
    v_fmac_f32 v35, v51, v74
    v_permlane32_swap_b32 v32, v34
    s_nop 0
    v_permlane32_swap_b32 v33, v35
    v_add_f32 v32, v32, v34
    v_add_f32 v33, v33, v35
    s_nop 1
    v_permlane16_swap_b32 v32, v33
    s_nop 0
    v_add_f32 v32, v32, v33
    v_cvt_pk_bf16_f32 v20, v32, v32
    v_cmp_u_f32 vcc, v32, v32
    s_cbranch_vccz L_pd_47
    s_sub_u32 s93, s93, 1
    s_cmp_gt_i32 s93, 0
    s_cbranch_scc1 L_x3poll
L_pd_47:
    ds_write_b16 v11, v20
    s_waitcnt lgkmcnt(0)
L_if_41:
    s_cbranch_execz L_nb_48
    s_barrier
L_nb_48:
    ds_read_b128 v[64:67], v56 offset:0
    ds_read_b128 v[68:71], v56 offset:64
    ds_read_b128 v[72:75], v57 offset:0
    ds_read_b128 v[76:79], v57 offset:64
    ds_read_b128 v[80:83], v58 offset:0
    ds_read_b128 v[84:87], v58 offset:64
    ds_read_b128 v[40:43], v59 offset:0
    ds_read_b128 v[44:47], v59 offset:64
    s_waitcnt lgkmcnt(7)
    v_mfma_f32_16x16x32_bf16 v[32:35], v[128:131], v[64:67], 0
    s_waitcnt lgkmcnt(6)
    v_mfma_f32_16x16x32_bf16 v[32:35], v[132:135], v[68:71], v[32:35]
    s_waitcnt lgkmcnt(5)
    v_mfma_f32_16x16x32_bf16 v[32:35], v[136:139], v[72:75], v[32:35]
    s_waitcnt lgkmcnt(4)
    v_mfma_f32_16x16x32_bf16 v[32:35], v[140:143], v[76:79], v[32:35]
    s_waitcnt lgkmcnt(3)
    v_mfma_f32_16x16x32_bf16 v[32:35], v[144:147], v[80:83], v[32:35]
    s_waitcnt lgkmcnt(2)
    v_mfma_f32_16x16x32_bf16 v[32:35], v[148:151], v[84:87], v[32:35]
    s_cmp_lt_u32 s3, 4
    s_cbranch_scc0 L_if_49
    s_waitcnt lgkmcnt(0)
    v_mfma_f32_16x16x32_bf16 v[32:35], v[152:155], v[40:43], v[32:35]
    v_mfma_f32_16x16x32_bf16 v[32:35], v[156:159], v[44:47], v[32:35]
L_if_49:
    s_nop 4
    s_cbranch_execz L_nm_50
    s_nop 1
    buffer_store_dwordx4 v[32:35], v28, s[4:7], 0 offen sc1
L_nm_50:
    s_branch L_T_skip
L_T_fl:
    s_cmp_eq_u32 s3, 4
    s_cbranch_scc0 L_if_51
    s_mov_b32 s93, 200000
    s_add_u32 s35, s36, 4096
L_x4apoll:
    s_cbranch_execz L_nm_52
    buffer_load_dwordx4 v[192:195], v3, s[4:7], s36 offen offset:0 sc1
    buffer_load_dwordx4 v[196:199], v3, s[4:7], s36 offen offset:1024 sc1
    buffer_load_dwordx4 v[200:203], v3, s[4:7], s36 offen offset:2048 sc1
    buffer_load_dwordx4 v[204:207], v3, s[4:7], s36 offen offset:3072 sc1
    buffer_load_dwordx4 v[208:211], v3, s[4:7], s35 offen offset:0 sc1
    buffer_load_dwordx4 v[212:215], v3, s[4:7], s35 offen offset:1024 sc1
    buffer_load_dwordx4 v[216:219], v3, s[4:7], s35 offen offset:2048 sc1
    buffer_load_dwordx4 v[220:223], v3, s[4:7], s35 offen offset:3072 sc1
    s_waitcnt vmcnt(0)
L_nm_52:
    v_pk_add_f32 v[192:193], v[192:193], v[208:209]
    v_pk_add_f32 v[194:195], v[194:195], v[210:211]
    v_pk_add_f32 v[196:197], v[196:197], v[212:213]
    v_pk_add_f32 v[198:199], v[198:199], v[214:215]
    v_pk_add_f32 v[200:201], v[200:201], v[216:217]
    v_pk_add_f32 v[202:203], v[202:203], v[218:219]
    v_pk_add_f32 v[204:205], v[204:205], v[220:221]
    v_pk_add_f32 v[206:207], v[206:207], v[222:223]
    v_pk_add_f32 v[192:193], v[192:193], v[200:201]
    v_pk_add_f32 v[194:195], v[194:195], v[202:203]
    v_pk_add_f32 v[196:197], v[196:197], v[204:205]
    v_pk_add_f32 v[198:199], v[198:199], v[206:207]
    v_pk_add_f32 v[32:33], v[192:193], v[196:197]
    v_pk_add_f32 v[34:35], v[194:195], v[198:199]
    v_cmp_u_f32 vcc, v32, v34
    s_cbranch_vccz L_pd_53
    s_sub_u32 s93, s93, 1
    s_cmp_gt_i32 s93, 0
    s_cbranch_scc1 L_x4apoll
L_pd_53:
    s_nop 0
    v_permlane32_swap_b32 v32, v34
    v_permlane32_swap_b32 v33, v35
    s_nop 0
    v_add_f32 v32, v32, v34
    v_add_f32 v33, v33, v35
    s_nop 1
    v_permlane16_swap_b32 v32, v33
    s_nop 0
    v_add_f32 v32, v32, v33
    s_nop 1
    v_add_f32_dpp v32, v32, v32 row_ror:8 row_mask:0xf bank_mask:0xf
    v_cmp_u_f32 vcc, v32, v32
    s_cbranch_vccz L_pd_54
    s_sub_u32 s93, s93, 1
    s_cmp_gt_i32 s93, 0
    s_cbranch_scc1 L_x4apoll
L_pd_54:
    v_cvt_pk_bf16_f32 v32, v32, v32
    v_and_b32 v32, 0xffff0000, v32
    v_mul_f32 v32, v32, v88
    v_cvt_pk_bf16_f32 v32, v32, v32
    v_and_b32 v32, 0xffff0000, v32
    v_add_f32 v92, v32, v91
    v_cvt_pk_bf16_f32 v92, v92, v92
    v_and_b32 v92, 0xffff0000, v92
    v_mul_f32 v32, v92, v90
    v_mov_b32 v40, v92
    v_mul_f32 v41, v92, v92
    v_mov_b32 v33, v32
    v_cvt_pk_bf16_f32 v33, v33, v33
    v_and_b32 v33, 0xffff0000, v33
    v_sub_f32 v32, v32, v33
    s_nop 0
    v_cndmask_b32 v33, v33, v32, s[60:61]
    v_mov_b32 v34, v33
    s_nop 1
    v_permlane16_swap_b32 v33, v34
    s_nop 0
    v_cvt_pk_bf16_f32 v33, v33, v34
    s_cbranch_execz L_nm_55
    s_cmp_eq_u32 s94, 0
    s_cbranch_scc1 L_loc_56
    buffer_store_dword v33, v22, s[4:7], 0 offen
    s_branch L_loc_57
L_loc_56:
    buffer_store_dword v33, v22, s[4:7], 0 offen sc1
L_loc_57:
L_nm_55:
    v_add_f32_dpp v40, v40, v40 quad_perm:[1,0,3,2] row_mask:0xf bank_mask:0xf
    v_add_f32_dpp v41, v41, v41 quad_perm:[1,0,3,2] row_mask:0xf bank_mask:0xf
    s_nop 0
    v_add_f32_dpp v40, v40, v40 quad_perm:[2,3,0,1] row_mask:0xf bank_mask:0xf
    v_add_f32_dpp v41, v41, v41 quad_perm:[2,3,0,1] row_mask:0xf bank_mask:0xf
    s_nop 0
    v_mov_b32 v34, v40
    v_mov_b32 v35, v41
    s_nop 0
    v_permlane16_swap_b32 v40, v34
    v_permlane16_swap_b32 v41, v35
    s_nop 0
    v_add_f32 v40, v40, v34
    v_add_f32 v41, v41, v35
    v_mov_b32 v34, v40
    v_mov_b32 v35, v41
    s_nop 0
    v_permlane32_swap_b32 v40, v34
    v_permlane32_swap_b32 v41, v35
    s_nop 0
    v_add_f32 v40, v40, v34
    v_add_f32 v41, v41, v35
    v_mul_f32 v34, v40, v40
    v_fma_f32 v41, -v34, s62, v41
    v_max_f32 v41, 0, v41
    s_cbranch_execz L_nm_58
    s_cmp_eq_u32 s94, 0
    s_cbranch_scc1 L_loc_59
    buffer_store_dwordx2 v[40:41], v23, s[4:7], 0 offen
    s_branch L_loc_60
L_loc_59:
    buffer_store_dwordx2 v[40:41], v23, s[4:7], 0 offen sc1
L_loc_60:
L_nm_58:
    s_mov_b32 s93, 200000
L_ypoll:
    s_cbranch_execz L_nm_61
    buffer_load_dwordx4 v[192:195], v3, s[4:7], s39 offen offset:0 sc1
    buffer_load_dwordx4 v[196:199], v3, s[4:7], s39 offen offset:1024 sc1
    buffer_load_dwordx4 v[200:203], v3, s[4:7], s39 offen offset:2048 sc1
    buffer_load_dwordx4 v[204:207], v12, s[4:7], s39 offen offset:3072 sc1
    buffer_load_dwordx2 v[40:41], v19, s[4:7], 0 offen sc1
    s_waitcnt vmcnt(0)
L_nm_61:
    v_max3_u32 v32, v192, v193, v194
    v_max3_u32 v33, v195, v196, v197
    v_max3_u32 v34, v198, v199, v200
    v_max3_u32 v32, v32, v201, v202
    v_max3_u32 v33, v33, v203, v204
    v_max3_u32 v34, v34, v205, v206
    v_max3_u32 v32, v32, v207, v40
    v_max3_u32 v32, v32, v33, v34
    v_cmp_eq_u32 vcc, -1, v32
    s_cbranch_vccz L_pd_62
    s_sub_u32 s93, s93, 1
    s_cmp_gt_i32 s93, 0
    s_cbranch_scc1 L_ypoll
L_pd_62:
    ds_write_b128 v25, v[192:195] offset:0
    ds_write_b128 v25, v[196:199] offset:1024
    ds_write_b128 v25, v[200:203] offset:2048
    ds_write_b128 v25, v[204:207] offset:3072
    ds_write_b64 v26, v[40:41]
    s_waitcnt lgkmcnt(0)
L_if_51:
    s_cbranch_execz L_nb_63
    s_barrier
L_nb_63:
    s_cmp_lt_u32 s3, 4
    s_cbranch_scc0 L_if_64
    ds_read_b64 v[40:41], v26
    ds_read_b128 v[128:131], v29 offset:0
    ds_read_b128 v[132:135], v29 offset:256
    ds_read_b128 v[136:139], v29 offset:512
    ds_read_b128 v[140:143], v29 offset:768
    ds_read_b128 v[144:147], v29 offset:1024
    ds_read_b128 v[148:151], v29 offset:1280
    ds_read_b128 v[152:155], v29 offset:1536
    ds_read_b128 v[156:159], v29 offset:1792
    ds_read_b128 v[160:163], v29 offset:2048
    ds_read_b128 v[164:167], v29 offset:2304
    ds_read_b128 v[168:171], v29 offset:2560
    ds_read_b128 v[172:175], v29 offset:2816
    ds_read_b128 v[176:179], v29 offset:3072
    ds_read_b128 v[180:183], v29 offset:3328
    s_waitcnt lgkmcnt(13)
    v_mfma_f32_16x16x32_bf16 v[32:35], v[192:195], v[128:131], 0
    v_mov_b32 v42, v40
    s_waitcnt lgkmcnt(12)
    v_mfma_f32_16x16x32_bf16 v[32:35], v[196:199], v[132:135], v[32:35]
    v_add_f32_dpp v42, v42, v42 row_ror:2 row_mask:0xf bank_mask:0xf
    s_waitcnt lgkmcnt(11)
    v_mfma_f32_16x16x32_bf16 v[32:35], v[200:203], v[136:139], v[32:35]
    v_add_f32_dpp v42, v42, v42 row_ror:4 row_mask:0xf bank_mask:0xf
    s_waitcnt lgkmcnt(10)
    v_mfma_f32_16x16x32_bf16 v[32:35], v[204:207], v[140:143], v[32:35]
    v_add_f32_dpp v42, v42, v42 row_ror:8 row_mask:0xf bank_mask:0xf
    s_waitcnt lgkmcnt(9)
    v_mfma_f32_16x16x32_bf16 v[32:35], v[208:211], v[144:147], v[32:35]
    v_mov_b32 v43, v42
    s_waitcnt lgkmcnt(8)
    v_mfma_f32_16x16x32_bf16 v[32:35], v[212:215], v[148:151], v[32:35]
    v_permlane16_swap_b32 v42, v43
    s_waitcnt lgkmcnt(7)
    v_mfma_f32_16x16x32_bf16 v[32:35], v[216:219], v[152:155], v[32:35]
    v_add_f32 v42, v42, v43
    v_mov_b32 v43, v42
    s_waitcnt lgkmcnt(6)
    v_mfma_f32_16x16x32_bf16 v[32:35], v[220:223], v[156:159], v[32:35]
    v_permlane32_swap_b32 v42, v43
    s_waitcnt lgkmcnt(5)
    v_mfma_f32_16x16x32_bf16 v[32:35], v[224:227], v[160:163], v[32:35]
    v_add_f32 v42, v42, v43
    v_mul_f32 v42, 0x3b124925, v42
    v_fma_f32 v43, v40, s62, -v42
    v_mul_f32 v43, v43, v43
    v_fmac_f32 v41, 0x41800000, v43
    v_mul_f32 v41, v41, v39
    s_waitcnt lgkmcnt(4)
    v_mfma_f32_16x16x32_bf16 v[32:35], v[228:231], v[164:167], v[32:35]
    v_add_f32_dpp v41, v41, v41 row_ror:2 row_mask:0xf bank_mask:0xf
    s_waitcnt lgkmcnt(3)
    v_mfma_f32_16x16x32_bf16 v[32:35], v[232:235], v[168:171], v[32:35]
    v_add_f32_dpp v41, v41, v41 row_ror:4 row_mask:0xf bank_mask:0xf
    s_waitcnt lgkmcnt(2)
    v_mfma_f32_16x16x32_bf16 v[32:35], v[236:239], v[172:175], v[32:35]
    v_add_f32_dpp v41, v41, v41 row_ror:8 row_mask:0xf bank_mask:0xf
    s_waitcnt lgkmcnt(1)
    v_mfma_f32_16x16x32_bf16 v[32:35], v[240:243], v[176:179], v[32:35]
    v_mov_b32 v43, v41
    s_waitcnt lgkmcnt(0)
    v_mfma_f32_16x16x32_bf16 v[32:35], v[244:247], v[180:183], v[32:35]
    v_permlane16_swap_b32 v41, v43
    s_nop 1
    v_add_f32 v41, v41, v43
    v_mov_b32 v43, v41
    s_nop 1
    v_permlane32_swap_b32 v41, v43
    s_nop 1
    v_add_f32 v41, v41, v43
    v_mul_f32 v41, 0x3b124925, v41
    v_cvt_pk_bf16_f32 v43, v42, v41
    v_lshlrev_b32 v42, 16, v43
    v_and_b32 v41, 0xffff0000, v43
    v_add_f32 v41, 0x3727c5ac, v41
    v_cvt_pk_bf16_f32 v41, v41, v41
    v_and_b32 v41, 0xffff0000, v41
    v_sqrt_f32 v41, v41
    v_cndmask_b32 v32, v32, v33, s[56:57]
    v_cvt_pk_bf16_f32 v41, v41, v41
    v_and_b32 v41, 0xffff0000, v41
    v_rcp_f32 v41, v41
    v_cndmask_b32 v34, v34, v35, s[56:57]
    v_cndmask_b32 v32, v32, v34, s[60:61]
    s_nop 1
    v_add_f32_dpp v32, v32, v32 quad_perm:[2,3,0,1] row_mask:0xf bank_mask:0xf
    v_fma_f32 v32, -v42, v248, v32
    v_fma_f32 v32, v32, v41, v252
    v_cvt_pk_bf16_f32 v32, v32, v32
    v_and_b32 v32, 0xffff0000, v32
    v_mul_f32 v33, 0xbfb8aa3b, v32
    v_exp_f32 v33, v33
    s_nop 0
    v_add_f32 v33, 1.0, v33
    v_rcp_f32 v33, v33
    s_nop 0
    v_mul_f32 v32, v32, v33
    v_cvt_pk_bf16_f32 v32, v32, v32
    ds_write_b16 v24, v32
    s_waitcnt lgkmcnt(0)
L_if_64:
    s_cbranch_execz L_nb_65
    s_barrier
L_nb_65:
    ds_read_b128 v[64:67], v56 offset:0
    ds_read_b128 v[68:71], v56 offset:64
    ds_read_b128 v[72:75], v57 offset:0
    ds_read_b128 v[76:79], v57 offset:64
    ds_read_b128 v[80:83], v58 offset:0
    ds_read_b128 v[84:87], v58 offset:64
    ds_read_b128 v[40:43], v59 offset:0
    ds_read_b128 v[44:47], v59 offset:64
    s_waitcnt lgkmcnt(7)
    v_mfma_f32_16x16x32_bf16 v[32:35], v[96:99], v[64:67], 0
    s_waitcnt lgkmcnt(6)
    v_mfma_f32_16x16x32_bf16 v[32:35], v[100:103], v[68:71], v[32:35]
    s_waitcnt lgkmcnt(5)
    v_mfma_f32_16x16x32_bf16 v[32:35], v[104:107], v[72:75], v[32:35]
    s_waitcnt lgkmcnt(4)
    v_mfma_f32_16x16x32_bf16 v[32:35], v[108:111], v[76:79], v[32:35]
    s_waitcnt lgkmcnt(3)
    v_mfma_f32_16x16x32_bf16 v[32:35], v[112:115], v[80:83], v[32:35]
    s_waitcnt lgkmcnt(2)
    v_mfma_f32_16x16x32_bf16 v[32:35], v[116:119], v[84:87], v[32:35]
    s_cmp_lt_u32 s3, 4
    s_cbranch_scc0 L_if_66
    s_waitcnt lgkmcnt(0)
    v_mfma_f32_16x16x32_bf16 v[32:35], v[120:123], v[40:43], v[32:35]
    v_mfma_f32_16x16x32_bf16 v[32:35], v[124:127], v[44:47], v[32:35]
L_if_66:
    s_nop 4
    s_cbranch_execz L_nm_67
    s_cmp_eq_u32 s94, 0
    s_cbranch_scc1 L_loc_68
    buffer_store_dwordx4 v[32:35], v28, s[4:7], 0 offen
    s_branch L_loc_69
L_loc_68:
    buffer_store_dwordx4 v[32:35], v28, s[4:7], 0 offen sc1
L_loc_69:
L_nm_67:
    s_cmp_eq_u32 s3, 4
    s_cbranch_scc0 L_if_70
    s_mov_b32 s93, 200000
L_x5poll:
    s_cbranch_execz L_nm_71
    buffer_load_dwordx4 v[192:195], v3, s[4:7], s37 offen offset:0 sc1
    buffer_load_dwordx4 v[196:199], v3, s[4:7], s37 offen offset:1024 sc1
    buffer_load_dwordx4 v[200:203], v3, s[4:7], s37 offen offset:2048 sc1
    buffer_load_dwordx4 v[204:207], v12, s[4:7], s37 offen offset:3072 sc1
    s_waitcnt vmcnt(0)
L_nm_71:
    v_pk_add_f32 v[192:193], v[192:193], v[200:201]
    v_pk_add_f32 v[194:195], v[194:195], v[202:203]
    v_pk_add_f32 v[196:197], v[196:197], v[204:205]
    v_pk_add_f32 v[198:199], v[198:199], v[206:207]
    v_pk_add_f32 v[32:33], v[192:193], v[196:197]
    v_pk_add_f32 v[34:35], v[194:195], v[198:199]
    v_cmp_u_f32 vcc, v32, v34
    s_cbranch_vccz L_pd_72
    s_sub_u32 s93, s93, 1
    s_cmp_gt_i32 s93, 0
    s_cbranch_scc1 L_x5poll
L_pd_72:
    s_nop 0
    v_permlane32_swap_b32 v32, v34
    v_permlane32_swap_b32 v33, v35
    s_nop 0
    v_add_f32 v32, v32, v34
    v_add_f32 v33, v33, v35
    s_nop 1
    v_permlane16_swap_b32 v32, v33
    s_nop 0
    v_add_f32 v32, v32, v33
    s_nop 1
    v_add_f32_dpp v32, v32, v32 row_ror:8 row_mask:0xf bank_mask:0xf
    v_cmp_u_f32 vcc, v32, v32
    s_cbranch_vccz L_pd_73
    s_sub_u32 s93, s93, 1
    s_cmp_gt_i32 s93, 0
    s_cbranch_scc1 L_x5poll
L_pd_73:
    v_cvt_pk_bf16_f32 v32, v32, v32
    v_and_b32 v32, 0xffff0000, v32
    v_mul_f32 v32, v32, v89
    v_cvt_pk_bf16_f32 v32, v32, v32
    v_and_b32 v32, 0xffff0000, v32
    v_add_f32 v32, v32, v92
    v_mov_b32 v34, v32
    s_nop 1
    v_permlane16_swap_b32 v32, v34
    s_nop 0
    v_cvt_pk_bf16_f32 v32, v32, v34
    s_cbranch_execz L_nm_74
    buffer_store_dword v32, v14, s[8:11], 0 offen
    s_cmp_eq_u32 s24, 0
    s_cbranch_scc0 L_if_75
    v_mov_b32 v38, s92
    buffer_store_dword v38, v13, s[4:7], 0 offen
L_if_75:
L_nm_74:
L_if_70:
L_T_skip:
    s_cbranch_execnz L_T_done
L_T_mid:
    s_mov_b64 exec, -1
    v_min_u32 v20, 27, v0
    v_lshlrev_b32 v20, 4, v20
    v_add_u32 v20, 20480, v20
    s_mov_b32 s93, 200000
L_idpoll:
    buffer_load_dwordx4 v[40:43], v20, s[4:7], 0 offen sc1
    s_waitcnt vmcnt(0)
    v_msad_u8 v32, v40, v31, 0
    v_msad_u8 v33, v41, v31, 0
    v_msad_u8 v32, v42, v31, v32
    v_msad_u8 v33, v43, v31, v33
    v_or_b32 v32, v32, v33
    v_cmp_ne_u32 vcc, 0, v32
    s_cbranch_vccz L_pd_76
    s_sub_u32 s93, s93, 1
    s_cmp_gt_i32 s93, 0
    s_cbranch_scc1 L_idpoll
L_pd_76:
    s_cmp_eq_u32 s38, 0
    s_cbranch_scc0 L_if_77
    s_barrier
    v_lshrrev_b32 v38, 2, v1
    v_lshl_add_u32 v36, v2, 3, v38
    v_lshlrev_b32 v36, 10, v36
    v_lshlrev_b32 v38, 1, v38
    v_and_b32 v37, 1, v2
    v_lshl_add_u32 v38, v37, 3, v38
    v_bfe_u32 v37, v1, 1, 1
    s_lshl_b32 s32, s3, 1
    v_add_u32 v37, s32, v37
    v_xor_b32 v38, v38, v37
    v_lshl_add_u32 v36, v38, 4, v36
    v_and_b32 v38, 1, v1
    v_lshl_add_u32 v36, v38, 3, v36
    v_add_u32 v36, 0, v36
    ds_read_b64_tr_b16 v[128:129], v36 offset:0
    ds_read_b64_tr_b16 v[130:131], v36 offset:4096
    ds_read_b64_tr_b16 v[132:133], v36 offset:32768
    ds_read_b64_tr_b16 v[134:135], v36 offset:36864
    ds_read_b64_tr_b16 v[136:137], v36 offset:256
    ds_read_b64_tr_b16 v[138:139], v36 offset:4352
    ds_read_b64_tr_b16 v[140:141], v36 offset:33024
    ds_read_b64_tr_b16 v[142:143], v36 offset:37120
    ds_read_b64_tr_b16 v[144:145], v36 offset:512
    ds_read_b64_tr_b16 v[146:147], v36 offset:4608
    ds_read_b64_tr_b16 v[148:149], v36 offset:33280
    ds_read_b64_tr_b16 v[150:151], v36 offset:37376
    s_cmp_lt_u32 s3, 4
    s_cbranch_scc0 L_if_78
    ds_read_b64_tr_b16 v[152:153], v36 offset:768
    ds_read_b64_tr_b16 v[154:155], v36 offset:4864
    ds_read_b64_tr_b16 v[156:157], v36 offset:33536
    ds_read_b64_tr_b16 v[158:159], v36 offset:37632
L_if_78:
    s_waitcnt lgkmcnt(0)
L_if_77:
    v_readfirstlane_b32 s32, v40
    s_nop 1
    v_cmp_ne_u32 vcc, s32, v40
    s_cmp_eq_u64 vcc, 0
    s_cselect_b32 s94, 1, 0
    s_cmp_eq_u32 s38, 1
    s_cbranch_scc0 L_if_79
    s_cmp_ge_u32 s3, 4
    s_cbranch_scc0 L_if_80
    s_lshr_b32 s31, s3, 1
    s_and_b32 s31, s31, 1
    s_and_b32 s32, s3, 1
    s_lshl_b32 s32, s32, 8
    v_lshlrev_b32 v21, 2, v0
    v_add_u32 v21, s32, v21
    v_min_u32 v21, 444, v21
    v_lshlrev_b32 v20, 1, v21
    v_lshrrev_b32 v38, 6, v21
    v_and_b32 v21, 63, v21
    v_lshlrev_b32 v21, 2, v21
    v_lshl_add_u32 v21, v38, 9, v21
    s_lshl_b32 s32, s31, 8
    s_add_u32 s32, s32, 69120
    s_lshl_b32 s31, s31, 10
    s_add_u32 s31, s31, 134144
    v_add_u32 v20, s31, v20
    s_lshr_b32 s34, s24, 2
    s_lshl_b32 s34, s34, 9
    s_and_b32 s35, s24, 3
    s_lshl_b32 s35, s35, 6
    s_add_u32 s34, s34, s35
    s_add_u32 s34, s34, 65536
    v_lshlrev_b32 v38, 8, v16
    v_lshl_add_u32 v38, v18, 2, v38
    v_add_u32 v38, s34, v38
    s_mov_b32 s34, 7168
    s_mov_b32 s35, 10752
    buffer_load_ushort v91, v15, s[12:15], 0 offen
    s_mov_b32 s93, 200000
L_x0poll:
    buffer_load_dwordx4 v[40:43], v21, s[4:7], s32 offen sc1
    buffer_load_dwordx4 v[44:47], v21, s[4:7], s32 offen offset:3584 sc1
    buffer_load_dword v88, v38, s[4:7], 0 offen sc1
    buffer_load_dword v90, v38, s[4:7], s34 offen sc1
    buffer_load_dword v89, v38, s[4:7], s35 offen sc1
    s_waitcnt vmcnt(0)
    v_msad_u8 v32, v40, v31, 0
    v_msad_u8 v33, v41, v31, 0
    v_msad_u8 v32, v42, v31, v32
    v_msad_u8 v33, v43, v31, v33
    v_msad_u8 v32, v44, v31, v32
    v_msad_u8 v33, v45, v31, v33
    v_msad_u8 v32, v46, v31, v32
    v_msad_u8 v33, v47, v31, v33
    v_msad_u8 v32, v88, v31, v32
    v_msad_u8 v33, v89, v31, v33
    v_msad_u8 v32, v90, v31, v32
    v_or_b32 v32, v32, v33
    v_cmp_ne_u32 vcc, 0, v32
    s_sleep 4
    s_cbranch_vccz L_pd_81
    s_sub_u32 s93, s93, 1
    s_cmp_gt_i32 s93, 0
    s_cbranch_scc1 L_x0poll
L_pd_81:
    v_and_b32 v40, 0xffff0000, v40
    v_and_b32 v41, 0xffff0000, v41
    v_and_b32 v42, 0xffff0000, v42
    v_and_b32 v43, 0xffff0000, v43
    v_and_b32 v44, 0xffff0000, v44
    v_and_b32 v45, 0xffff0000, v45
    v_and_b32 v46, 0xffff0000, v46
    v_and_b32 v47, 0xffff0000, v47
    v_and_b32 v88, 0xffff0000, v88
    v_and_b32 v89, 0xffff0000, v89
    v_and_b32 v90, 0xffff0000, v90
    v_add_f32 v44, 1.0, v44
    v_add_f32 v45, 1.0, v45
    v_add_f32 v46, 1.0, v46
    v_add_f32 v47, 1.0, v47
    v_add_f32 v90, 1.0, v90
    v_cvt_pk_bf16_f32 v32, v44, v45
    v_cvt_pk_bf16_f32 v33, v46, v47
    v_cvt_pk_bf16_f32 v34, v40, v41
    v_cvt_pk_bf16_f32 v35, v42, v43
    ds_write_b64 v20, v[32:33]
    ds_write_b64 v20, v[34:35] offset:2048
    v_cvt_pk_bf16_f32 v90, v90, v90
    v_and_b32 v90, 0xffff0000, v90
    v_lshlrev_b32 v91, 16, v91
L_if_80:
    s_waitcnt vmcnt(0) lgkmcnt(0)
    s_barrier
    v_lshrrev_b32 v38, 2, v1
    v_lshl_add_u32 v36, v2, 3, v38
    v_lshlrev_b32 v36, 10, v36
    v_lshlrev_b32 v38, 1, v38
    v_and_b32 v37, 1, v2
    v_lshl_add_u32 v38, v37, 3, v38
    v_bfe_u32 v37, v1, 1, 1
    s_lshl_b32 s32, s3, 1
    v_add_u32 v37, s32, v37
    v_xor_b32 v38, v38, v37
    v_lshl_add_u32 v36, v38, 4, v36
    v_and_b32 v38, 1, v1
    v_lshl_add_u32 v36, v38, 3, v36
    v_add_u32 v36, 57344, v36
    ds_read_b64_tr_b16 v[96:97], v36 offset:0
    ds_read_b64_tr_b16 v[98:99], v36 offset:4096
    ds_read_b64_tr_b16 v[100:101], v36 offset:32768
    ds_read_b64_tr_b16 v[102:103], v36 offset:36864
    ds_read_b64_tr_b16 v[104:105], v36 offset:256
    ds_read_b64_tr_b16 v[106:107], v36 offset:4352
    ds_read_b64_tr_b16 v[108:109], v36 offset:33024
    ds_read_b64_tr_b16 v[110:111], v36 offset:37120
    ds_read_b64_tr_b16 v[112:113], v36 offset:512
    ds_read_b64_tr_b16 v[114:115], v36 offset:4608
    ds_read_b64_tr_b16 v[116:117], v36 offset:33280
    ds_read_b64_tr_b16 v[118:119], v36 offset:37376
    s_cmp_lt_u32 s3, 4
    s_cbranch_scc0 L_if_82
    ds_read_b64_tr_b16 v[120:121], v36 offset:768
    ds_read_b64_tr_b16 v[122:123], v36 offset:4864
    ds_read_b64_tr_b16 v[124:125], v36 offset:33536
    ds_read_b64_tr_b16 v[126:127], v36 offset:37632
L_if_82:
    s_cmp_lt_u32 s3, 4
    s_cbranch_scc0 L_if_83
    s_waitcnt lgkmcnt(0)
    s_and_b32 s34, s3, 3
    v_lshrrev_b32 v38, 2, v1
    v_lshl_add_u32 v36, v2, 3, v38
    v_lshlrev_b32 v36, 7, v36
    v_and_b32 v38, 2, v38
    v_and_b32 v37, 1, v2
    v_lshl_add_u32 v38, v37, 2, v38
    v_bfe_u32 v37, v1, 1, 1
    s_lshl_b32 s32, s34, 1
    v_add_u32 v37, s32, v37
    v_xor_b32 v38, v38, v37
    v_lshl_add_u32 v36, v38, 4, v36
    v_and_b32 v38, 1, v1
    v_lshl_add_u32 v36, v38, 3, v36
    ds_read_b64_tr_b16 v[192:193], v36 offset:0
    ds_read_b64_tr_b16 v[194:195], v36 offset:512
    ds_read_b64_tr_b16 v[196:197], v36 offset:4096
    ds_read_b64_tr_b16 v[198:199], v36 offset:4608
    ds_read_b64_tr_b16 v[200:201], v36 offset:8192
    ds_read_b64_tr_b16 v[202:203], v36 offset:8704
    ds_read_b64_tr_b16 v[204:205], v36 offset:12288
    ds_read_b64_tr_b16 v[206:207], v36 offset:12800
    ds_read_b64_tr_b16 v[208:209], v36 offset:16384
    ds_read_b64_tr_b16 v[210:211], v36 offset:16896
    ds_read_b64_tr_b16 v[212:213], v36 offset:20480
    ds_read_b64_tr_b16 v[214:215], v36 offset:20992
    ds_read_b64_tr_b16 v[216:217], v36 offset:24576
    ds_read_b64_tr_b16 v[218:219], v36 offset:25088
    ds_read_b64_tr_b16 v[220:221], v36 offset:28672
    ds_read_b64_tr_b16 v[222:223], v36 offset:29184
    ds_read_b64_tr_b16 v[224:225], v36 offset:32768
    ds_read_b64_tr_b16 v[226:227], v36 offset:33280
    ds_read_b64_tr_b16 v[228:229], v36 offset:36864
    ds_read_b64_tr_b16 v[230:231], v36 offset:37376
    ds_read_b64_tr_b16 v[232:233], v36 offset:40960
    ds_read_b64_tr_b16 v[234:235], v36 offset:41472
    ds_read_b64_tr_b16 v[236:237], v36 offset:45056
    ds_read_b64_tr_b16 v[238:239], v36 offset:45568
    ds_read_b64_tr_b16 v[240:241], v36 offset:49152
    ds_read_b64_tr_b16 v[242:243], v36 offset:49664
    ds_read_b64_tr_b16 v[244:245], v36 offset:53248
    ds_read_b64_tr_b16 v[246:247], v36 offset:53760
    ds_read_b128 v[128:131], v27 offset:0
    ds_read_b128 v[132:135], v27 offset:64
    ds_read_b128 v[136:139], v27 offset:128
    ds_read_b128 v[140:143], v27 offset:192
    ds_read_b128 v[144:147], v27 offset:256
    ds_read_b128 v[148:151], v27 offset:320
    ds_read_b128 v[152:155], v27 offset:384
    ds_read_b128 v[156:159], v27 offset:448
    ds_read_b128 v[160:163], v27 offset:512
    ds_read_b128 v[164:167], v27 offset:576
    ds_read_b128 v[168:171], v27 offset:640
    ds_read_b128 v[172:175], v27 offset:704
    ds_read_b128 v[176:179], v27 offset:768
    ds_read_b128 v[180:183], v27 offset:832
    s_waitcnt lgkmcnt(0)
    v_mfma_f32_16x16x32_bf16 v[32:35], v[192:195], v[128:131], 0
    v_mfma_f32_16x16x32_bf16 v[32:35], v[196:199], v[132:135], v[32:35]
    v_mfma_f32_16x16x32_bf16 v[32:35], v[200:203], v[136:139], v[32:35]
    v_mfma_f32_16x16x32_bf16 v[32:35], v[204:207], v[140:143], v[32:35]
    v_mfma_f32_16x16x32_bf16 v[32:35], v[208:211], v[144:147], v[32:35]
    v_mfma_f32_16x16x32_bf16 v[32:35], v[212:215], v[148:151], v[32:35]
    v_mfma_f32_16x16x32_bf16 v[32:35], v[216:219], v[152:155], v[32:35]
    v_mfma_f32_16x16x32_bf16 v[32:35], v[220:223], v[156:159], v[32:35]
    v_mfma_f32_16x16x32_bf16 v[32:35], v[224:227], v[160:163], v[32:35]
    v_mfma_f32_16x16x32_bf16 v[32:35], v[228:231], v[164:167], v[32:35]
    v_mfma_f32_16x16x32_bf16 v[32:35], v[232:235], v[168:171], v[32:35]
    v_mfma_f32_16x16x32_bf16 v[32:35], v[236:239], v[172:175], v[32:35]
    v_mfma_f32_16x16x32_bf16 v[32:35], v[240:243], v[176:179], v[32:35]
    v_mfma_f32_16x16x32_bf16 v[32:35], v[244:247], v[180:183], v[32:35]
    s_nop 9
    v_cndmask_b32 v32, v32, v33, s[56:57]
    v_cndmask_b32 v34, v34, v35, s[56:57]
    v_cndmask_b32 v32, v32, v34, s[60:61]
    s_nop 1
    v_mov_b32_dpp v248, v32 quad_perm:[0,1,0,1] row_mask:0xf bank_mask:0xf
    v_mov_b32_dpp v252, v32 quad_perm:[2,3,2,3] row_mask:0xf bank_mask:0xf
L_if_83:
    s_waitcnt lgkmcnt(0)
L_if_79:
    s_branch L_T_top
L_T_done:
    s_endpgm
L_exit:
    s_endpgm
.section .rodata,"a"
.p2align 6
.amdhsa_kernel adaLN_cond__sliding_block_cached__dense_activation_silu__decode_kernel
  .amdhsa_next_free_vgpr 256
  .amdhsa_next_free_sgpr 102
  .amdhsa_accum_offset 256
  .amdhsa_group_segment_fixed_size 0
  .amdhsa_kernarg_size 104
  .amdhsa_user_sgpr_count 2
  .amdhsa_user_sgpr_kernarg_segment_ptr 1
  .amdhsa_system_sgpr_workgroup_id_x 1
.end_amdhsa_kernel
```
